```python
import torch

def _softmax(x, axis=-1):
    return torch.softmax(x, dim=axis)
def _gelu(x):
    return torch.nn.functional.gelu(x, approximate="tanh")
def _silu(x):
    return torch.nn.functional.silu(x)
def _sigmoid(x):
    return torch.sigmoid(x)
def _layernorm(x, axis=-1, eps=1e-5):
    m = x.mean(dim=axis, keepdim=True)
    v = x.var(dim=axis, keepdim=True, unbiased=False)
    return (x - m) / torch.sqrt(v + eps)
def _scatter_add(tgt, idx, src, axis=0):
    return tgt.clone().index_add_(axis, idx, src)
def _segment_sum(src, seg, n):
    out = torch.zeros((n,) + src.shape[1:], dtype=src.dtype)
    return out.index_add_(0, seg, src)
def _pad(x, pw):
    flat = tuple(v for pair in reversed(pw) for v in pair)
    return torch.nn.functional.pad(x, flat)

kernel_name = 'standalone__gqa_block_cached__near_ridge'

def setup_inputs():

    _w = (lambda a: (lambda t: t.to(torch.bfloat16) if t.is_floating_point() else t)(torch.as_tensor(a)))
    B, Sq, D = 16, 48, 448
    Hq, Hkv, Sk, Dh = 16, 8, 48, 256
    assert Hq % Hkv == 0, (Hq, Hkv)
    return {
        "x": _w((lambda *s: torch.randn(*s, dtype=torch.bfloat16) * 0.8)(B, Sq, D)),
        "k_cache": _w((lambda *s: torch.randn(*s, dtype=torch.bfloat16) * 0.8)(B, Hkv, Sk, Dh)),
        "v_cache": _w((lambda *s: torch.randn(*s, dtype=torch.bfloat16) * 0.05)(B, Hkv, Sk, Dh)),
        "wq": _w((lambda *s: torch.randn(*s, dtype=torch.bfloat16) * 0.8)(D, Hq * Dh) * (D ** -0.5)),
        "wo": _w((lambda *s: torch.randn(*s, dtype=torch.bfloat16) * 0.05)(Hq * Dh, D) * ((Hq * Dh) ** -0.5)),
    }

def reference(x, k_cache, v_cache, wq, wo):
    B, Sq, D = x.shape
    Hq, Dh = 16, 256
    Hkv = k_cache.shape[1]
    rep = Hq // Hkv
    q = (lambda x, *d: x.permute(*d))((x @ wq).reshape(B, Sq, Hq, Dh), 0, 2, 1, 3)
    k = (lambda x, n, axis: torch.repeat_interleave(x, n, dim=axis))(k_cache, rep, axis=1)
    v = (lambda x, n, axis: torch.repeat_interleave(x, n, dim=axis))(v_cache, rep, axis=1)
    scores = torch.einsum("bhqd,bhkd->bhqk", q, k) * (Dh ** -0.5)
    p = _softmax(scores, axis=-1)
    o = torch.einsum("bhqk,bhkd->bhqd", p, v)
    return (lambda x, *d: x.permute(*d))(o, 0, 2, 1, 3).reshape(B, Sq, Hq * Dh) @ wo
```

```asm
; @launch kernel=k1_kernel grid=(256,1,1) block=(256,1,1) lds=153600
; @launch kernel=k2_kernel grid=(168,1,1) block=(256,1,1) lds=0
.amdgcn_target "amdgcn-amd-amdhsa--gfx950"
.text
.globl k1_kernel
.p2align 8
.type k1_kernel,@function
k1_kernel:
    s_cmp_ge_u32 s2, 256
    s_cbranch_scc1 K1_END
    s_load_dwordx16 s[4:19], s[0:1], 0
    v_and_b32 v1, 63, v0
    v_lshrrev_b32 v28, 6, v0
    v_and_b32 v2, 15, v1
    v_lshrrev_b32 v3, 4, v1
    v_readfirstlane_b32 s46, v28
    s_and_b32 s47, s2, 7
    s_lshr_b32 s48, s2, 3
    s_and_b32 s49, s48, 1
    s_lshl_b32 s45, s47, 1
    s_add_u32 s45, s45, s49
    s_lshr_b32 s44, s48, 1
    v_mul_u32_u24 v4, 896, v2
    v_lshl_add_u32 v4, v3, 4, v4
    v_lshrrev_b32 v28, 3, v1
    v_and_b32 v29, 7, v1
    v_lshrrev_b32 v30, 1, v28
    v_and_b32 v31, 1, v30
    v_lshlrev_b32 v31, 1, v31
    v_xor_b32 v31, v29, v31
    v_lshlrev_b32 v5, 13, v28
    v_lshl_add_u32 v5, v31, 4, v5
    v_xor_b32 v31, 4, v31
    v_lshlrev_b32 v6, 13, v28
    v_lshl_add_u32 v6, v31, 4, v6
    v_and_b32 v31, 3, v30
    v_lshlrev_b32 v31, 1, v31
    v_xor_b32 v31, v29, v31
    v_lshlrev_b32 v7, 9, v28
    v_lshl_add_u32 v7, v31, 4, v7
    s_movk_i32 s58, 4682
    v_add_u32 v28, 0, v1
    v_mul_u32_u24 v29, s58, v28
    v_lshrrev_b32 v29, 16, v29
    v_mul_u32_u24 v30, 14, v29
    v_sub_u32 v30, v28, v30
    v_mul_u32_u24 v8, 896, v29
    v_lshl_add_u32 v8, v30, 4, v8
    v_add_u32 v28, 64, v1
    v_mul_u32_u24 v29, s58, v28
    v_lshrrev_b32 v29, 16, v29
    v_mul_u32_u24 v30, 14, v29
    v_sub_u32 v30, v28, v30
    v_mul_u32_u24 v9, 896, v29
    v_lshl_add_u32 v9, v30, 4, v9
    v_add_u32 v28, 128, v1
    v_mul_u32_u24 v29, s58, v28
    v_lshrrev_b32 v29, 16, v29
    v_mul_u32_u24 v30, 14, v29
    v_sub_u32 v30, v28, v30
    v_mul_u32_u24 v10, 896, v29
    v_lshl_add_u32 v10, v30, 4, v10
    v_add_u32 v28, 192, v1
    v_mul_u32_u24 v29, s58, v28
    v_lshrrev_b32 v29, 16, v29
    v_mul_u32_u24 v30, 14, v29
    v_sub_u32 v30, v28, v30
    v_mul_u32_u24 v11, 896, v29
    v_lshl_add_u32 v11, v30, 4, v11
    v_add_u32 v28, 256, v1
    v_mul_u32_u24 v29, s58, v28
    v_lshrrev_b32 v29, 16, v29
    v_mul_u32_u24 v30, 14, v29
    v_sub_u32 v30, v28, v30
    v_mul_u32_u24 v12, 896, v29
    v_lshl_add_u32 v12, v30, 4, v12
    v_add_u32 v28, 320, v1
    v_mul_u32_u24 v29, s58, v28
    v_lshrrev_b32 v29, 16, v29
    v_mul_u32_u24 v30, 14, v29
    v_sub_u32 v30, v28, v30
    v_mul_u32_u24 v13, 896, v29
    v_lshl_add_u32 v13, v30, 4, v13
    v_add_u32 v28, 384, v1
    v_mul_u32_u24 v29, s58, v28
    v_lshrrev_b32 v29, 16, v29
    v_mul_u32_u24 v30, 14, v29
    v_sub_u32 v30, v28, v30
    v_mul_u32_u24 v14, 896, v29
    v_lshl_add_u32 v14, v30, 4, v14
    v_lshlrev_b32 v15, 9, v2
    v_lshl_add_u32 v15, v3, 3, v15
    v_lshlrev_b32 v25, 4, v1
    v_lshlrev_b32 v26, 3, v1
    v_lshrrev_b32 v28, 2, v1
    v_and_b32 v28, 3, v28
    v_and_b32 v29, 3, v1
    s_waitcnt lgkmcnt(0)
    s_mov_b32 s20, s4
    s_mov_b32 s21, s5
    s_mov_b32 s22, 688128
    s_mov_b32 s23, 0x00020000
    s_mov_b32 s24, s6
    s_mov_b32 s25, s7
    s_mov_b32 s26, 3145728
    s_mov_b32 s27, 0x00020000
    s_mov_b32 s28, s8
    s_mov_b32 s29, s9
    s_mov_b32 s30, 3145728
    s_mov_b32 s31, 0x00020000
    s_mov_b32 s32, s10
    s_mov_b32 s33, s11
    s_mov_b32 s34, 3670016
    s_mov_b32 s35, 0x00020000
    s_mov_b32 s36, s12
    s_mov_b32 s37, s13
    s_mov_b32 s38, 3670016
    s_mov_b32 s39, 0x00020000
    s_mov_b32 s40, s18
    s_mov_b32 s41, s19
    s_mov_b32 s42, 11010048
    s_mov_b32 s43, 0x00020000
    s_mov_b32 s96, s14
    s_mov_b32 s97, s15
    s_mov_b32 s98, 688128
    s_mov_b32 s99, 0x00020000
    s_mul_i32 s50, s44, 43008
    s_lshl_b32 s58, s46, 7
    s_lshl_b32 s51, s45, 9
    s_add_u32 s51, s51, s58
    s_lshr_b32 s59, s45, 1
    s_lshl_b32 s60, s44, 3
    s_add_u32 s59, s59, s60
    s_mul_i32 s52, s59, 24576
    s_add_u32 s52, s52, s58
    s_mov_b32 s53, s52
    s_add_u32 s62, s52, 8192
    s_add_u32 s63, s52, 16384
    s_mul_i32 s54, s45, 229376
    s_mul_i32 s58, s46, 224
    s_add_u32 s54, s54, s58
    s_mul_i32 s55, s45, 1376256
    s_mul_i32 s58, s44, 86016
    s_add_u32 s55, s55, s58
    s_mul_i32 s58, s46, 448
    s_add_u32 s55, s55, s58
    s_add_u32 s64, s55, 28672
    s_add_u32 s65, s55, 57344
    s_mul_i32 s57, s46, 27648
    s_add_u32 s57, s57, 43008
    s_add_u32 s56, s57, 6144
    s_mov_b32 s61, 0x3db8aa3b
    s_cmp_ge_u32 s44, 14
    s_cselect_b32 s58, 14, 0
    s_sub_u32 s47, s44, s58
    s_mov_b32 s48, s47
    s_and_b32 s49, s44, 7
    s_mov_b32 s3, s49
    s_add_u32 s58, s46, 0
    s_mul_i32 s59, s58, 3072
    s_lshl_b32 s60, s58, 6
    s_add_u32 s60, s60, s50
    s_add_u32 m0, s59, 0
    s_nop 0
    buffer_load_dwordx4 v4, s[20:23], s60 offen lds
    s_add_u32 m0, s59, 1024
    s_add_u32 s60, s60, 14336
    buffer_load_dwordx4 v4, s[20:23], s60 offen lds
    s_add_u32 m0, s59, 2048
    s_add_u32 s60, s60, 14336
    buffer_load_dwordx4 v4, s[20:23], s60 offen lds
    s_add_u32 s58, s46, 4
    s_mul_i32 s59, s58, 3072
    s_lshl_b32 s60, s58, 6
    s_add_u32 s60, s60, s50
    s_add_u32 m0, s59, 0
    s_nop 0
    buffer_load_dwordx4 v4, s[20:23], s60 offen lds
    s_add_u32 m0, s59, 1024
    s_add_u32 s60, s60, 14336
    buffer_load_dwordx4 v4, s[20:23], s60 offen lds
    s_add_u32 m0, s59, 2048
    s_add_u32 s60, s60, 14336
    buffer_load_dwordx4 v4, s[20:23], s60 offen lds
    s_add_u32 s58, s46, 8
    s_mul_i32 s59, s58, 3072
    s_lshl_b32 s60, s58, 6
    s_add_u32 s60, s60, s50
    s_add_u32 m0, s59, 0
    s_nop 0
    buffer_load_dwordx4 v4, s[20:23], s60 offen lds
    s_add_u32 m0, s59, 1024
    s_add_u32 s60, s60, 14336
    buffer_load_dwordx4 v4, s[20:23], s60 offen lds
    s_add_u32 m0, s59, 2048
    s_add_u32 s60, s60, 14336
    buffer_load_dwordx4 v4, s[20:23], s60 offen lds
    s_and_b32 s58, s46, 1
    s_add_u32 s58, s58, 12
    s_mul_i32 s59, s58, 3072
    s_lshl_b32 s60, s58, 6
    s_add_u32 s60, s60, s50
    s_add_u32 m0, s59, 0
    s_nop 0
    buffer_load_dwordx4 v4, s[20:23], s60 offen lds
    s_add_u32 m0, s59, 1024
    s_add_u32 s60, s60, 14336
    buffer_load_dwordx4 v4, s[20:23], s60 offen lds
    s_add_u32 m0, s59, 2048
    s_add_u32 s60, s60, 14336
    buffer_load_dwordx4 v4, s[20:23], s60 offen lds
    s_lshl_b32 s59, s47, 18
    s_add_u32 s59, s59, s51
    s_add_u32 m0, s56, 0
    s_add_u32 s58, s59, 0
    buffer_load_dwordx4 v5, s[32:35], s58 offen lds
    s_add_u32 m0, s56, 1024
    s_add_u32 s58, s59, 65536
    buffer_load_dwordx4 v6, s[32:35], s58 offen lds
    s_add_u32 m0, s56, 2048
    s_add_u32 s58, s59, 131072
    buffer_load_dwordx4 v5, s[32:35], s58 offen lds
    s_add_u32 m0, s56, 3072
    s_add_u32 s58, s59, 196608
    buffer_load_dwordx4 v6, s[32:35], s58 offen lds
    s_add_u32 s47, s47, 1
    s_cmp_eq_u32 s47, 14
    s_cselect_b32 s47, 0, s47
    s_lshl_b32 s59, s47, 18
    s_add_u32 s59, s59, s51
    s_add_u32 m0, s56, 4096
    s_add_u32 s58, s59, 0
    buffer_load_dwordx4 v5, s[32:35], s58 offen lds
    s_add_u32 m0, s56, 5120
    s_add_u32 s58, s59, 65536
    buffer_load_dwordx4 v6, s[32:35], s58 offen lds
    s_add_u32 m0, s56, 6144
    s_add_u32 s58, s59, 131072
    buffer_load_dwordx4 v5, s[32:35], s58 offen lds
    s_add_u32 m0, s56, 7168
    s_add_u32 s58, s59, 196608
    buffer_load_dwordx4 v6, s[32:35], s58 offen lds
    s_add_u32 s47, s47, 1
    s_cmp_eq_u32 s47, 14
    s_cselect_b32 s47, 0, s47
    s_lshl_b32 s59, s47, 18
    s_add_u32 s59, s59, s51
    s_add_u32 m0, s56, 8192
    s_add_u32 s58, s59, 0
    buffer_load_dwordx4 v5, s[32:35], s58 offen lds
    s_add_u32 m0, s56, 9216
    s_add_u32 s58, s59, 65536
    buffer_load_dwordx4 v6, s[32:35], s58 offen lds
    s_add_u32 m0, s56, 10240
    s_add_u32 s58, s59, 131072
    buffer_load_dwordx4 v5, s[32:35], s58 offen lds
    s_add_u32 m0, s56, 11264
    s_add_u32 s58, s59, 196608
    buffer_load_dwordx4 v6, s[32:35], s58 offen lds
    s_add_u32 s47, s47, 1
    s_cmp_eq_u32 s47, 14
    s_cselect_b32 s47, 0, s47
    s_lshl_b32 s59, s47, 18
    s_add_u32 s59, s59, s51
    s_add_u32 m0, s56, 12288
    s_add_u32 s58, s59, 0
    buffer_load_dwordx4 v5, s[32:35], s58 offen lds
    s_add_u32 m0, s56, 13312
    s_add_u32 s58, s59, 65536
    buffer_load_dwordx4 v6, s[32:35], s58 offen lds
    s_add_u32 m0, s56, 14336
    s_add_u32 s58, s59, 131072
    buffer_load_dwordx4 v5, s[32:35], s58 offen lds
    s_add_u32 m0, s56, 15360
    s_add_u32 s58, s59, 196608
    buffer_load_dwordx4 v6, s[32:35], s58 offen lds
    s_add_u32 s47, s47, 1
    s_cmp_eq_u32 s47, 14
    s_cselect_b32 s47, 0, s47
    s_lshl_b32 s59, s47, 18
    s_add_u32 s59, s59, s51
    s_add_u32 m0, s56, 16384
    s_add_u32 s58, s59, 0
    buffer_load_dwordx4 v5, s[32:35], s58 offen lds
    s_add_u32 m0, s56, 17408
    s_add_u32 s58, s59, 65536
    buffer_load_dwordx4 v6, s[32:35], s58 offen lds
    s_add_u32 m0, s56, 18432
    s_add_u32 s58, s59, 131072
    buffer_load_dwordx4 v5, s[32:35], s58 offen lds
    s_add_u32 m0, s56, 19456
    s_add_u32 s58, s59, 196608
    buffer_load_dwordx4 v6, s[32:35], s58 offen lds
    s_add_u32 s47, s47, 1
    s_cmp_eq_u32 s47, 14
    s_cselect_b32 s47, 0, s47
    buffer_load_dwordx2 v[32:33], v15, s[24:27], s52 offen offset:0
    buffer_load_dwordx2 v[34:35], v15, s[24:27], s52 offen offset:32
    buffer_load_dwordx2 v[36:37], v15, s[24:27], s52 offen offset:64
    buffer_load_dwordx2 v[38:39], v15, s[24:27], s52 offen offset:96
    buffer_load_dwordx2 v[40:41], v15, s[24:27], s62 offen offset:0
    buffer_load_dwordx2 v[42:43], v15, s[24:27], s62 offen offset:32
    buffer_load_dwordx2 v[44:45], v15, s[24:27], s62 offen offset:64
    buffer_load_dwordx2 v[46:47], v15, s[24:27], s62 offen offset:96
    buffer_load_dwordx2 v[48:49], v15, s[24:27], s63 offen offset:0
    buffer_load_dwordx2 v[50:51], v15, s[24:27], s63 offen offset:32
    buffer_load_dwordx2 v[52:53], v15, s[24:27], s63 offen offset:64
    buffer_load_dwordx2 v[54:55], v15, s[24:27], s63 offen offset:96
    s_add_u32 m0, s57, 0
    s_add_u32 s58, s53, 0
    buffer_load_dwordx4 v7, s[28:31], s58 offen lds
    s_add_u32 m0, s57, 1024
    s_add_u32 s58, s53, 4096
    buffer_load_dwordx4 v7, s[28:31], s58 offen lds
    s_add_u32 m0, s57, 2048
    s_add_u32 s58, s53, 8192
    buffer_load_dwordx4 v7, s[28:31], s58 offen lds
    s_add_u32 m0, s57, 3072
    s_add_u32 s58, s53, 12288
    buffer_load_dwordx4 v7, s[28:31], s58 offen lds
    s_add_u32 m0, s57, 4096
    s_add_u32 s58, s53, 16384
    buffer_load_dwordx4 v7, s[28:31], s58 offen lds
    s_add_u32 m0, s57, 5120
    s_add_u32 s58, s53, 20480
    buffer_load_dwordx4 v7, s[28:31], s58 offen lds
    v_lshrrev_b32 v28, 2, v1
    v_and_b32 v28, 3, v28
    v_and_b32 v29, 3, v1
    v_lshrrev_b32 v30, 1, v28
    v_and_b32 v31, 1, v3
    v_lshl_or_b32 v31, v31, 1, v30
    v_lshl_add_u32 v16, v3, 3, v28
    v_lshlrev_b32 v16, 7, v16
    v_lshl_add_u32 v16, v29, 3, v16
    v_add_u32 v16, s56, v16
    v_xor_b32 v24, 3, v31
    v_lshl_add_u32 v19, v24, 5, v16
    v_xor_b32 v24, 2, v31
    v_lshl_add_u32 v18, v24, 5, v16
    v_xor_b32 v24, 1, v31
    v_lshl_add_u32 v17, v24, 5, v16
    v_xor_b32 v24, 0, v31
    v_lshl_add_u32 v16, v24, 5, v16
    v_lshl_add_u32 v31, v3, 1, v30
    v_and_b32 v31, 3, v31
    v_lshl_add_u32 v20, v3, 2, v28
    v_mul_u32_u24 v24, 224, v20
    v_lshlrev_b32 v20, 7, v20
    v_lshl_add_u32 v20, v29, 3, v20
    v_add_u32 v20, s57, v20
    v_xor_b32 v27, 3, v31
    v_lshl_add_u32 v23, v27, 5, v20
    v_xor_b32 v27, 2, v31
    v_lshl_add_u32 v22, v27, 5, v20
    v_xor_b32 v27, 1, v31
    v_lshl_add_u32 v21, v27, 5, v20
    v_xor_b32 v27, 0, v31
    v_lshl_add_u32 v20, v27, 5, v20
    v_lshl_add_u32 v24, v29, 3, v24
    v_add_u32 v24, s56, v24
    v_mul_u32_u24 v27, 1792, v2
    v_lshl_add_u32 v27, v3, 4, v27
    s_waitcnt vmcnt(38)
    s_barrier
    s_waitcnt vmcnt(34)
    s_mul_i32 s58, s48, 3072
    v_add_u32 v30, s58, v25
    s_add_u32 s48, s48, 1
    s_cmp_eq_u32 s48, 14
    s_cselect_b32 s48, 0, s48
    ds_read_b64_tr_b16 v[112:113], v16 offset:0
    ds_read_b64_tr_b16 v[114:115], v16 offset:512
    ds_read_b64_tr_b16 v[116:117], v17 offset:0
    ds_read_b64_tr_b16 v[118:119], v17 offset:512
    ds_read_b64_tr_b16 v[120:121], v18 offset:0
    ds_read_b64_tr_b16 v[122:123], v18 offset:512
    ds_read_b64_tr_b16 v[124:125], v19 offset:0
    ds_read_b64_tr_b16 v[126:127], v19 offset:512
    ds_read_b128 v[144:147], v30 offset:0
    ds_read_b128 v[148:151], v30 offset:1024
    ds_read_b128 v[152:155], v30 offset:2048
    s_waitcnt vmcnt(30)
    s_mul_i32 s58, s48, 3072
    v_add_u32 v31, s58, v25
    s_add_u32 s48, s48, 1
    s_cmp_eq_u32 s48, 14
    s_cselect_b32 s48, 0, s48
    s_waitcnt lgkmcnt(0)
    ds_read_b64_tr_b16 v[128:129], v16 offset:4096
    v_mfma_f32_16x16x32_bf16 v[64:67], v[112:115], v[144:147], 0
    ds_read_b64_tr_b16 v[130:131], v16 offset:4608
    v_mfma_f32_16x16x32_bf16 v[68:71], v[112:115], v[148:151], 0
    ds_read_b64_tr_b16 v[132:133], v17 offset:4096
    v_mfma_f32_16x16x32_bf16 v[72:75], v[112:115], v[152:155], 0
    ds_read_b64_tr_b16 v[134:135], v17 offset:4608
    v_mfma_f32_16x16x32_bf16 v[76:79], v[116:119], v[144:147], 0
    ds_read_b64_tr_b16 v[136:137], v18 offset:4096
    v_mfma_f32_16x16x32_bf16 v[80:83], v[116:119], v[148:151], 0
    ds_read_b64_tr_b16 v[138:139], v18 offset:4608
    v_mfma_f32_16x16x32_bf16 v[84:87], v[116:119], v[152:155], 0
    ds_read_b64_tr_b16 v[140:141], v19 offset:4096
    v_mfma_f32_16x16x32_bf16 v[88:91], v[120:123], v[144:147], 0
    ds_read_b64_tr_b16 v[142:143], v19 offset:4608
    v_mfma_f32_16x16x32_bf16 v[92:95], v[120:123], v[148:151], 0
    ds_read_b128 v[156:159], v31 offset:0
    v_mfma_f32_16x16x32_bf16 v[96:99], v[120:123], v[152:155], 0
    ds_read_b128 v[160:163], v31 offset:1024
    v_mfma_f32_16x16x32_bf16 v[100:103], v[124:127], v[144:147], 0
    ds_read_b128 v[164:167], v31 offset:2048
    v_mfma_f32_16x16x32_bf16 v[104:107], v[124:127], v[148:151], 0
    v_mfma_f32_16x16x32_bf16 v[108:111], v[124:127], v[152:155], 0
    s_lshl_b32 s59, s47, 18
    s_add_u32 s59, s59, s51
    s_add_u32 m0, s56, 0
    s_add_u32 s58, s59, 0
    buffer_load_dwordx4 v5, s[32:35], s58 offen lds
    s_add_u32 m0, s56, 1024
    s_add_u32 s58, s59, 65536
    buffer_load_dwordx4 v6, s[32:35], s58 offen lds
    s_add_u32 m0, s56, 2048
    s_add_u32 s58, s59, 131072
    buffer_load_dwordx4 v5, s[32:35], s58 offen lds
    s_add_u32 m0, s56, 3072
    s_add_u32 s58, s59, 196608
    buffer_load_dwordx4 v6, s[32:35], s58 offen lds
    s_add_u32 s47, s47, 1
    s_cmp_eq_u32 s47, 14
    s_cselect_b32 s47, 0, s47
    s_waitcnt vmcnt(30)
    s_mul_i32 s58, s48, 3072
    v_add_u32 v30, s58, v25
    s_add_u32 s48, s48, 1
    s_cmp_eq_u32 s48, 14
    s_cselect_b32 s48, 0, s48
    s_waitcnt lgkmcnt(0)
    ds_read_b64_tr_b16 v[112:113], v16 offset:8192
    v_mfma_f32_16x16x32_bf16 v[64:67], v[128:131], v[156:159], v[64:67]
    ds_read_b64_tr_b16 v[114:115], v16 offset:8704
    v_mfma_f32_16x16x32_bf16 v[68:71], v[128:131], v[160:163], v[68:71]
    ds_read_b64_tr_b16 v[116:117], v17 offset:8192
    v_mfma_f32_16x16x32_bf16 v[72:75], v[128:131], v[164:167], v[72:75]
    ds_read_b64_tr_b16 v[118:119], v17 offset:8704
    v_mfma_f32_16x16x32_bf16 v[76:79], v[132:135], v[156:159], v[76:79]
    ds_read_b64_tr_b16 v[120:121], v18 offset:8192
    v_mfma_f32_16x16x32_bf16 v[80:83], v[132:135], v[160:163], v[80:83]
    ds_read_b64_tr_b16 v[122:123], v18 offset:8704
    v_mfma_f32_16x16x32_bf16 v[84:87], v[132:135], v[164:167], v[84:87]
    ds_read_b64_tr_b16 v[124:125], v19 offset:8192
    v_mfma_f32_16x16x32_bf16 v[88:91], v[136:139], v[156:159], v[88:91]
    ds_read_b64_tr_b16 v[126:127], v19 offset:8704
    v_mfma_f32_16x16x32_bf16 v[92:95], v[136:139], v[160:163], v[92:95]
    ds_read_b128 v[144:147], v30 offset:0
    v_mfma_f32_16x16x32_bf16 v[96:99], v[136:139], v[164:167], v[96:99]
    ds_read_b128 v[148:151], v30 offset:1024
    v_mfma_f32_16x16x32_bf16 v[100:103], v[140:143], v[156:159], v[100:103]
    ds_read_b128 v[152:155], v30 offset:2048
    v_mfma_f32_16x16x32_bf16 v[104:107], v[140:143], v[160:163], v[104:107]
    v_mfma_f32_16x16x32_bf16 v[108:111], v[140:143], v[164:167], v[108:111]
    s_lshl_b32 s59, s47, 18
    s_add_u32 s59, s59, s51
    s_add_u32 m0, s56, 4096
    s_add_u32 s58, s59, 0
    buffer_load_dwordx4 v5, s[32:35], s58 offen lds
    s_add_u32 m0, s56, 5120
    s_add_u32 s58, s59, 65536
    buffer_load_dwordx4 v6, s[32:35], s58 offen lds
    s_add_u32 m0, s56, 6144
    s_add_u32 s58, s59, 131072
    buffer_load_dwordx4 v5, s[32:35], s58 offen lds
    s_add_u32 m0, s56, 7168
    s_add_u32 s58, s59, 196608
    buffer_load_dwordx4 v6, s[32:35], s58 offen lds
    s_add_u32 s47, s47, 1
    s_cmp_eq_u32 s47, 14
    s_cselect_b32 s47, 0, s47
    s_waitcnt vmcnt(30)
    s_mul_i32 s58, s48, 3072
    v_add_u32 v31, s58, v25
    s_add_u32 s48, s48, 1
    s_cmp_eq_u32 s48, 14
    s_cselect_b32 s48, 0, s48
    s_waitcnt lgkmcnt(0)
    ds_read_b64_tr_b16 v[128:129], v16 offset:12288
    v_mfma_f32_16x16x32_bf16 v[64:67], v[112:115], v[144:147], v[64:67]
    ds_read_b64_tr_b16 v[130:131], v16 offset:12800
    v_mfma_f32_16x16x32_bf16 v[68:71], v[112:115], v[148:151], v[68:71]
    ds_read_b64_tr_b16 v[132:133], v17 offset:12288
    v_mfma_f32_16x16x32_bf16 v[72:75], v[112:115], v[152:155], v[72:75]
    ds_read_b64_tr_b16 v[134:135], v17 offset:12800
    v_mfma_f32_16x16x32_bf16 v[76:79], v[116:119], v[144:147], v[76:79]
    ds_read_b64_tr_b16 v[136:137], v18 offset:12288
    v_mfma_f32_16x16x32_bf16 v[80:83], v[116:119], v[148:151], v[80:83]
    ds_read_b64_tr_b16 v[138:139], v18 offset:12800
    v_mfma_f32_16x16x32_bf16 v[84:87], v[116:119], v[152:155], v[84:87]
    ds_read_b64_tr_b16 v[140:141], v19 offset:12288
    v_mfma_f32_16x16x32_bf16 v[88:91], v[120:123], v[144:147], v[88:91]
    ds_read_b64_tr_b16 v[142:143], v19 offset:12800
    v_mfma_f32_16x16x32_bf16 v[92:95], v[120:123], v[148:151], v[92:95]
    ds_read_b128 v[156:159], v31 offset:0
    v_mfma_f32_16x16x32_bf16 v[96:99], v[120:123], v[152:155], v[96:99]
    ds_read_b128 v[160:163], v31 offset:1024
    v_mfma_f32_16x16x32_bf16 v[100:103], v[124:127], v[144:147], v[100:103]
    ds_read_b128 v[164:167], v31 offset:2048
    v_mfma_f32_16x16x32_bf16 v[104:107], v[124:127], v[148:151], v[104:107]
    v_mfma_f32_16x16x32_bf16 v[108:111], v[124:127], v[152:155], v[108:111]
    s_lshl_b32 s59, s47, 18
    s_add_u32 s59, s59, s51
    s_add_u32 m0, s56, 8192
    s_add_u32 s58, s59, 0
    buffer_load_dwordx4 v5, s[32:35], s58 offen lds
    s_add_u32 m0, s56, 9216
    s_add_u32 s58, s59, 65536
    buffer_load_dwordx4 v6, s[32:35], s58 offen lds
    s_add_u32 m0, s56, 10240
    s_add_u32 s58, s59, 131072
    buffer_load_dwordx4 v5, s[32:35], s58 offen lds
    s_add_u32 m0, s56, 11264
    s_add_u32 s58, s59, 196608
    buffer_load_dwordx4 v6, s[32:35], s58 offen lds
    s_add_u32 s47, s47, 1
    s_cmp_eq_u32 s47, 14
    s_cselect_b32 s47, 0, s47
    s_waitcnt vmcnt(30)
    s_mul_i32 s58, s48, 3072
    v_add_u32 v30, s58, v25
    s_add_u32 s48, s48, 1
    s_cmp_eq_u32 s48, 14
    s_cselect_b32 s48, 0, s48
    s_waitcnt lgkmcnt(0)
    ds_read_b64_tr_b16 v[112:113], v16 offset:16384
    v_mfma_f32_16x16x32_bf16 v[64:67], v[128:131], v[156:159], v[64:67]
    ds_read_b64_tr_b16 v[114:115], v16 offset:16896
    v_mfma_f32_16x16x32_bf16 v[68:71], v[128:131], v[160:163], v[68:71]
    ds_read_b64_tr_b16 v[116:117], v17 offset:16384
    v_mfma_f32_16x16x32_bf16 v[72:75], v[128:131], v[164:167], v[72:75]
    ds_read_b64_tr_b16 v[118:119], v17 offset:16896
    v_mfma_f32_16x16x32_bf16 v[76:79], v[132:135], v[156:159], v[76:79]
    ds_read_b64_tr_b16 v[120:121], v18 offset:16384
    v_mfma_f32_16x16x32_bf16 v[80:83], v[132:135], v[160:163], v[80:83]
    ds_read_b64_tr_b16 v[122:123], v18 offset:16896
    v_mfma_f32_16x16x32_bf16 v[84:87], v[132:135], v[164:167], v[84:87]
    ds_read_b64_tr_b16 v[124:125], v19 offset:16384
    v_mfma_f32_16x16x32_bf16 v[88:91], v[136:139], v[156:159], v[88:91]
    ds_read_b64_tr_b16 v[126:127], v19 offset:16896
    v_mfma_f32_16x16x32_bf16 v[92:95], v[136:139], v[160:163], v[92:95]
    ds_read_b128 v[144:147], v30 offset:0
    v_mfma_f32_16x16x32_bf16 v[96:99], v[136:139], v[164:167], v[96:99]
    ds_read_b128 v[148:151], v30 offset:1024
    v_mfma_f32_16x16x32_bf16 v[100:103], v[140:143], v[156:159], v[100:103]
    ds_read_b128 v[152:155], v30 offset:2048
    v_mfma_f32_16x16x32_bf16 v[104:107], v[140:143], v[160:163], v[104:107]
    v_mfma_f32_16x16x32_bf16 v[108:111], v[140:143], v[164:167], v[108:111]
    s_lshl_b32 s59, s47, 18
    s_add_u32 s59, s59, s51
    s_add_u32 m0, s56, 12288
    s_add_u32 s58, s59, 0
    buffer_load_dwordx4 v5, s[32:35], s58 offen lds
    s_add_u32 m0, s56, 13312
    s_add_u32 s58, s59, 65536
    buffer_load_dwordx4 v6, s[32:35], s58 offen lds
    s_add_u32 m0, s56, 14336
    s_add_u32 s58, s59, 131072
    buffer_load_dwordx4 v5, s[32:35], s58 offen lds
    s_add_u32 m0, s56, 15360
    s_add_u32 s58, s59, 196608
    buffer_load_dwordx4 v6, s[32:35], s58 offen lds
    s_add_u32 s47, s47, 1
    s_cmp_eq_u32 s47, 14
    s_cselect_b32 s47, 0, s47
    s_waitcnt vmcnt(12)
    s_mul_i32 s58, s48, 3072
    v_add_u32 v31, s58, v25
    s_add_u32 s48, s48, 1
    s_cmp_eq_u32 s48, 14
    s_cselect_b32 s48, 0, s48
    s_waitcnt lgkmcnt(0)
    ds_read_b64_tr_b16 v[128:129], v16 offset:0
    v_mfma_f32_16x16x32_bf16 v[64:67], v[112:115], v[144:147], v[64:67]
    ds_read_b64_tr_b16 v[130:131], v16 offset:512
    v_mfma_f32_16x16x32_bf16 v[68:71], v[112:115], v[148:151], v[68:71]
    ds_read_b64_tr_b16 v[132:133], v17 offset:0
    v_mfma_f32_16x16x32_bf16 v[72:75], v[112:115], v[152:155], v[72:75]
    ds_read_b64_tr_b16 v[134:135], v17 offset:512
    v_mfma_f32_16x16x32_bf16 v[76:79], v[116:119], v[144:147], v[76:79]
    ds_read_b64_tr_b16 v[136:137], v18 offset:0
    v_mfma_f32_16x16x32_bf16 v[80:83], v[116:119], v[148:151], v[80:83]
    ds_read_b64_tr_b16 v[138:139], v18 offset:512
    v_mfma_f32_16x16x32_bf16 v[84:87], v[116:119], v[152:155], v[84:87]
    ds_read_b64_tr_b16 v[140:141], v19 offset:0
    v_mfma_f32_16x16x32_bf16 v[88:91], v[120:123], v[144:147], v[88:91]
    ds_read_b64_tr_b16 v[142:143], v19 offset:512
    v_mfma_f32_16x16x32_bf16 v[92:95], v[120:123], v[148:151], v[92:95]
    ds_read_b128 v[156:159], v31 offset:0
    v_mfma_f32_16x16x32_bf16 v[96:99], v[120:123], v[152:155], v[96:99]
    ds_read_b128 v[160:163], v31 offset:1024
    v_mfma_f32_16x16x32_bf16 v[100:103], v[124:127], v[144:147], v[100:103]
    ds_read_b128 v[164:167], v31 offset:2048
    v_mfma_f32_16x16x32_bf16 v[104:107], v[124:127], v[148:151], v[104:107]
    v_mfma_f32_16x16x32_bf16 v[108:111], v[124:127], v[152:155], v[108:111]
    s_lshl_b32 s59, s47, 18
    s_add_u32 s59, s59, s51
    s_add_u32 m0, s56, 16384
    s_add_u32 s58, s59, 0
    buffer_load_dwordx4 v5, s[32:35], s58 offen lds
    s_add_u32 m0, s56, 17408
    s_add_u32 s58, s59, 65536
    buffer_load_dwordx4 v6, s[32:35], s58 offen lds
    s_add_u32 m0, s56, 18432
    s_add_u32 s58, s59, 131072
    buffer_load_dwordx4 v5, s[32:35], s58 offen lds
    s_add_u32 m0, s56, 19456
    s_add_u32 s58, s59, 196608
    buffer_load_dwordx4 v6, s[32:35], s58 offen lds
    s_add_u32 s47, s47, 1
    s_cmp_eq_u32 s47, 14
    s_cselect_b32 s47, 0, s47
    s_waitcnt vmcnt(12)
    s_mul_i32 s58, s48, 3072
    v_add_u32 v30, s58, v25
    s_add_u32 s48, s48, 1
    s_cmp_eq_u32 s48, 14
    s_cselect_b32 s48, 0, s48
    s_waitcnt lgkmcnt(0)
    ds_read_b64_tr_b16 v[112:113], v16 offset:4096
    v_mfma_f32_16x16x32_bf16 v[64:67], v[128:131], v[156:159], v[64:67]
    ds_read_b64_tr_b16 v[114:115], v16 offset:4608
    v_mfma_f32_16x16x32_bf16 v[68:71], v[128:131], v[160:163], v[68:71]
    ds_read_b64_tr_b16 v[116:117], v17 offset:4096
    v_mfma_f32_16x16x32_bf16 v[72:75], v[128:131], v[164:167], v[72:75]
    ds_read_b64_tr_b16 v[118:119], v17 offset:4608
    v_mfma_f32_16x16x32_bf16 v[76:79], v[132:135], v[156:159], v[76:79]
    ds_read_b64_tr_b16 v[120:121], v18 offset:4096
    v_mfma_f32_16x16x32_bf16 v[80:83], v[132:135], v[160:163], v[80:83]
    ds_read_b64_tr_b16 v[122:123], v18 offset:4608
    v_mfma_f32_16x16x32_bf16 v[84:87], v[132:135], v[164:167], v[84:87]
    ds_read_b64_tr_b16 v[124:125], v19 offset:4096
    v_mfma_f32_16x16x32_bf16 v[88:91], v[136:139], v[156:159], v[88:91]
    ds_read_b64_tr_b16 v[126:127], v19 offset:4608
    v_mfma_f32_16x16x32_bf16 v[92:95], v[136:139], v[160:163], v[92:95]
    ds_read_b128 v[144:147], v30 offset:0
    v_mfma_f32_16x16x32_bf16 v[96:99], v[136:139], v[164:167], v[96:99]
    ds_read_b128 v[148:151], v30 offset:1024
    v_mfma_f32_16x16x32_bf16 v[100:103], v[140:143], v[156:159], v[100:103]
    ds_read_b128 v[152:155], v30 offset:2048
    v_mfma_f32_16x16x32_bf16 v[104:107], v[140:143], v[160:163], v[104:107]
    v_mfma_f32_16x16x32_bf16 v[108:111], v[140:143], v[164:167], v[108:111]
    s_lshl_b32 s59, s47, 18
    s_add_u32 s59, s59, s51
    s_add_u32 m0, s56, 0
    s_add_u32 s58, s59, 0
    buffer_load_dwordx4 v5, s[32:35], s58 offen lds
    s_add_u32 m0, s56, 1024
    s_add_u32 s58, s59, 65536
    buffer_load_dwordx4 v6, s[32:35], s58 offen lds
    s_add_u32 m0, s56, 2048
    s_add_u32 s58, s59, 131072
    buffer_load_dwordx4 v5, s[32:35], s58 offen lds
    s_add_u32 m0, s56, 3072
    s_add_u32 s58, s59, 196608
    buffer_load_dwordx4 v6, s[32:35], s58 offen lds
    s_add_u32 s47, s47, 1
    s_cmp_eq_u32 s47, 14
    s_cselect_b32 s47, 0, s47
    s_waitcnt vmcnt(12)
    s_mul_i32 s58, s48, 3072
    v_add_u32 v31, s58, v25
    s_add_u32 s48, s48, 1
    s_cmp_eq_u32 s48, 14
    s_cselect_b32 s48, 0, s48
    s_waitcnt lgkmcnt(0)
    ds_read_b64_tr_b16 v[128:129], v16 offset:8192
    v_mfma_f32_16x16x32_bf16 v[64:67], v[112:115], v[144:147], v[64:67]
    ds_read_b64_tr_b16 v[130:131], v16 offset:8704
    v_mfma_f32_16x16x32_bf16 v[68:71], v[112:115], v[148:151], v[68:71]
    ds_read_b64_tr_b16 v[132:133], v17 offset:8192
    v_mfma_f32_16x16x32_bf16 v[72:75], v[112:115], v[152:155], v[72:75]
    ds_read_b64_tr_b16 v[134:135], v17 offset:8704
    v_mfma_f32_16x16x32_bf16 v[76:79], v[116:119], v[144:147], v[76:79]
    ds_read_b64_tr_b16 v[136:137], v18 offset:8192
    v_mfma_f32_16x16x32_bf16 v[80:83], v[116:119], v[148:151], v[80:83]
    ds_read_b64_tr_b16 v[138:139], v18 offset:8704
    v_mfma_f32_16x16x32_bf16 v[84:87], v[116:119], v[152:155], v[84:87]
    ds_read_b64_tr_b16 v[140:141], v19 offset:8192
    v_mfma_f32_16x16x32_bf16 v[88:91], v[120:123], v[144:147], v[88:91]
    ds_read_b64_tr_b16 v[142:143], v19 offset:8704
    v_mfma_f32_16x16x32_bf16 v[92:95], v[120:123], v[148:151], v[92:95]
    ds_read_b128 v[156:159], v31 offset:0
    v_mfma_f32_16x16x32_bf16 v[96:99], v[120:123], v[152:155], v[96:99]
    ds_read_b128 v[160:163], v31 offset:1024
    v_mfma_f32_16x16x32_bf16 v[100:103], v[124:127], v[144:147], v[100:103]
    ds_read_b128 v[164:167], v31 offset:2048
    v_mfma_f32_16x16x32_bf16 v[104:107], v[124:127], v[148:151], v[104:107]
    v_mfma_f32_16x16x32_bf16 v[108:111], v[124:127], v[152:155], v[108:111]
    s_lshl_b32 s59, s47, 18
    s_add_u32 s59, s59, s51
    s_add_u32 m0, s56, 4096
    s_add_u32 s58, s59, 0
    buffer_load_dwordx4 v5, s[32:35], s58 offen lds
    s_add_u32 m0, s56, 5120
    s_add_u32 s58, s59, 65536
    buffer_load_dwordx4 v6, s[32:35], s58 offen lds
    s_add_u32 m0, s56, 6144
    s_add_u32 s58, s59, 131072
    buffer_load_dwordx4 v5, s[32:35], s58 offen lds
    s_add_u32 m0, s56, 7168
    s_add_u32 s58, s59, 196608
    buffer_load_dwordx4 v6, s[32:35], s58 offen lds
    s_add_u32 s47, s47, 1
    s_cmp_eq_u32 s47, 14
    s_cselect_b32 s47, 0, s47
    s_waitcnt vmcnt(12)
    s_mul_i32 s58, s48, 3072
    v_add_u32 v30, s58, v25
    s_add_u32 s48, s48, 1
    s_cmp_eq_u32 s48, 14
    s_cselect_b32 s48, 0, s48
    s_waitcnt lgkmcnt(0)
    ds_read_b64_tr_b16 v[112:113], v16 offset:12288
    v_mfma_f32_16x16x32_bf16 v[64:67], v[128:131], v[156:159], v[64:67]
    ds_read_b64_tr_b16 v[114:115], v16 offset:12800
    v_mfma_f32_16x16x32_bf16 v[68:71], v[128:131], v[160:163], v[68:71]
    ds_read_b64_tr_b16 v[116:117], v17 offset:12288
    v_mfma_f32_16x16x32_bf16 v[72:75], v[128:131], v[164:167], v[72:75]
    ds_read_b64_tr_b16 v[118:119], v17 offset:12800
    v_mfma_f32_16x16x32_bf16 v[76:79], v[132:135], v[156:159], v[76:79]
    ds_read_b64_tr_b16 v[120:121], v18 offset:12288
    v_mfma_f32_16x16x32_bf16 v[80:83], v[132:135], v[160:163], v[80:83]
    ds_read_b64_tr_b16 v[122:123], v18 offset:12800
    v_mfma_f32_16x16x32_bf16 v[84:87], v[132:135], v[164:167], v[84:87]
    ds_read_b64_tr_b16 v[124:125], v19 offset:12288
    v_mfma_f32_16x16x32_bf16 v[88:91], v[136:139], v[156:159], v[88:91]
    ds_read_b64_tr_b16 v[126:127], v19 offset:12800
    v_mfma_f32_16x16x32_bf16 v[92:95], v[136:139], v[160:163], v[92:95]
    ds_read_b128 v[144:147], v30 offset:0
    v_mfma_f32_16x16x32_bf16 v[96:99], v[136:139], v[164:167], v[96:99]
    ds_read_b128 v[148:151], v30 offset:1024
    v_mfma_f32_16x16x32_bf16 v[100:103], v[140:143], v[156:159], v[100:103]
    ds_read_b128 v[152:155], v30 offset:2048
    v_mfma_f32_16x16x32_bf16 v[104:107], v[140:143], v[160:163], v[104:107]
    v_mfma_f32_16x16x32_bf16 v[108:111], v[140:143], v[164:167], v[108:111]
    s_lshl_b32 s59, s47, 18
    s_add_u32 s59, s59, s51
    s_add_u32 m0, s56, 8192
    s_add_u32 s58, s59, 0
    buffer_load_dwordx4 v5, s[32:35], s58 offen lds
    s_add_u32 m0, s56, 9216
    s_add_u32 s58, s59, 65536
    buffer_load_dwordx4 v6, s[32:35], s58 offen lds
    s_add_u32 m0, s56, 10240
    s_add_u32 s58, s59, 131072
    buffer_load_dwordx4 v5, s[32:35], s58 offen lds
    s_add_u32 m0, s56, 11264
    s_add_u32 s58, s59, 196608
    buffer_load_dwordx4 v6, s[32:35], s58 offen lds
    s_add_u32 s47, s47, 1
    s_cmp_eq_u32 s47, 14
    s_cselect_b32 s47, 0, s47
    s_waitcnt vmcnt(12)
    s_mul_i32 s58, s48, 3072
    v_add_u32 v31, s58, v25
    s_add_u32 s48, s48, 1
    s_cmp_eq_u32 s48, 14
    s_cselect_b32 s48, 0, s48
    s_waitcnt lgkmcnt(0)
    ds_read_b64_tr_b16 v[128:129], v16 offset:16384
    v_mfma_f32_16x16x32_bf16 v[64:67], v[112:115], v[144:147], v[64:67]
    ds_read_b64_tr_b16 v[130:131], v16 offset:16896
    v_mfma_f32_16x16x32_bf16 v[68:71], v[112:115], v[148:151], v[68:71]
    ds_read_b64_tr_b16 v[132:133], v17 offset:16384
    v_mfma_f32_16x16x32_bf16 v[72:75], v[112:115], v[152:155], v[72:75]
    ds_read_b64_tr_b16 v[134:135], v17 offset:16896
    v_mfma_f32_16x16x32_bf16 v[76:79], v[116:119], v[144:147], v[76:79]
    ds_read_b64_tr_b16 v[136:137], v18 offset:16384
    v_mfma_f32_16x16x32_bf16 v[80:83], v[116:119], v[148:151], v[80:83]
    ds_read_b64_tr_b16 v[138:139], v18 offset:16896
    v_mfma_f32_16x16x32_bf16 v[84:87], v[116:119], v[152:155], v[84:87]
    ds_read_b64_tr_b16 v[140:141], v19 offset:16384
    v_mfma_f32_16x16x32_bf16 v[88:91], v[120:123], v[144:147], v[88:91]
    ds_read_b64_tr_b16 v[142:143], v19 offset:16896
    v_mfma_f32_16x16x32_bf16 v[92:95], v[120:123], v[148:151], v[92:95]
    ds_read_b128 v[156:159], v31 offset:0
    v_mfma_f32_16x16x32_bf16 v[96:99], v[120:123], v[152:155], v[96:99]
    ds_read_b128 v[160:163], v31 offset:1024
    v_mfma_f32_16x16x32_bf16 v[100:103], v[124:127], v[144:147], v[100:103]
    ds_read_b128 v[164:167], v31 offset:2048
    v_mfma_f32_16x16x32_bf16 v[104:107], v[124:127], v[148:151], v[104:107]
    v_mfma_f32_16x16x32_bf16 v[108:111], v[124:127], v[152:155], v[108:111]
    s_lshl_b32 s59, s47, 18
    s_add_u32 s59, s59, s51
    s_add_u32 m0, s56, 12288
    s_add_u32 s58, s59, 0
    buffer_load_dwordx4 v5, s[32:35], s58 offen lds
    s_add_u32 m0, s56, 13312
    s_add_u32 s58, s59, 65536
    buffer_load_dwordx4 v6, s[32:35], s58 offen lds
    s_add_u32 m0, s56, 14336
    s_add_u32 s58, s59, 131072
    buffer_load_dwordx4 v5, s[32:35], s58 offen lds
    s_add_u32 m0, s56, 15360
    s_add_u32 s58, s59, 196608
    buffer_load_dwordx4 v6, s[32:35], s58 offen lds
    s_add_u32 s47, s47, 1
    s_cmp_eq_u32 s47, 14
    s_cselect_b32 s47, 0, s47
    s_waitcnt vmcnt(12)
    s_mul_i32 s58, s48, 3072
    v_add_u32 v30, s58, v25
    s_add_u32 s48, s48, 1
    s_cmp_eq_u32 s48, 14
    s_cselect_b32 s48, 0, s48
    s_waitcnt lgkmcnt(0)
    ds_read_b64_tr_b16 v[112:113], v16 offset:0
    v_mfma_f32_16x16x32_bf16 v[64:67], v[128:131], v[156:159], v[64:67]
    ds_read_b64_tr_b16 v[114:115], v16 offset:512
    v_mfma_f32_16x16x32_bf16 v[68:71], v[128:131], v[160:163], v[68:71]
    ds_read_b64_tr_b16 v[116:117], v17 offset:0
    v_mfma_f32_16x16x32_bf16 v[72:75], v[128:131], v[164:167], v[72:75]
    ds_read_b64_tr_b16 v[118:119], v17 offset:512
    v_mfma_f32_16x16x32_bf16 v[76:79], v[132:135], v[156:159], v[76:79]
    ds_read_b64_tr_b16 v[120:121], v18 offset:0
    v_mfma_f32_16x16x32_bf16 v[80:83], v[132:135], v[160:163], v[80:83]
    ds_read_b64_tr_b16 v[122:123], v18 offset:512
    v_mfma_f32_16x16x32_bf16 v[84:87], v[132:135], v[164:167], v[84:87]
    ds_read_b64_tr_b16 v[124:125], v19 offset:0
    v_mfma_f32_16x16x32_bf16 v[88:91], v[136:139], v[156:159], v[88:91]
    ds_read_b64_tr_b16 v[126:127], v19 offset:512
    v_mfma_f32_16x16x32_bf16 v[92:95], v[136:139], v[160:163], v[92:95]
    ds_read_b128 v[144:147], v30 offset:0
    v_mfma_f32_16x16x32_bf16 v[96:99], v[136:139], v[164:167], v[96:99]
    ds_read_b128 v[148:151], v30 offset:1024
    v_mfma_f32_16x16x32_bf16 v[100:103], v[140:143], v[156:159], v[100:103]
    ds_read_b128 v[152:155], v30 offset:2048
    v_mfma_f32_16x16x32_bf16 v[104:107], v[140:143], v[160:163], v[104:107]
    v_mfma_f32_16x16x32_bf16 v[108:111], v[140:143], v[164:167], v[108:111]
    s_waitcnt vmcnt(8)
    s_mul_i32 s58, s48, 3072
    v_add_u32 v31, s58, v25
    s_add_u32 s48, s48, 1
    s_cmp_eq_u32 s48, 14
    s_cselect_b32 s48, 0, s48
    s_waitcnt lgkmcnt(0)
    ds_read_b64_tr_b16 v[128:129], v16 offset:4096
    v_mfma_f32_16x16x32_bf16 v[64:67], v[112:115], v[144:147], v[64:67]
    ds_read_b64_tr_b16 v[130:131], v16 offset:4608
    v_mfma_f32_16x16x32_bf16 v[68:71], v[112:115], v[148:151], v[68:71]
    ds_read_b64_tr_b16 v[132:133], v17 offset:4096
    v_mfma_f32_16x16x32_bf16 v[72:75], v[112:115], v[152:155], v[72:75]
    ds_read_b64_tr_b16 v[134:135], v17 offset:4608
    v_mfma_f32_16x16x32_bf16 v[76:79], v[116:119], v[144:147], v[76:79]
    ds_read_b64_tr_b16 v[136:137], v18 offset:4096
    v_mfma_f32_16x16x32_bf16 v[80:83], v[116:119], v[148:151], v[80:83]
    ds_read_b64_tr_b16 v[138:139], v18 offset:4608
    v_mfma_f32_16x16x32_bf16 v[84:87], v[116:119], v[152:155], v[84:87]
    ds_read_b64_tr_b16 v[140:141], v19 offset:4096
    v_mfma_f32_16x16x32_bf16 v[88:91], v[120:123], v[144:147], v[88:91]
    ds_read_b64_tr_b16 v[142:143], v19 offset:4608
    v_mfma_f32_16x16x32_bf16 v[92:95], v[120:123], v[148:151], v[92:95]
    ds_read_b128 v[156:159], v31 offset:0
    v_mfma_f32_16x16x32_bf16 v[96:99], v[120:123], v[152:155], v[96:99]
    ds_read_b128 v[160:163], v31 offset:1024
    v_mfma_f32_16x16x32_bf16 v[100:103], v[124:127], v[144:147], v[100:103]
    ds_read_b128 v[164:167], v31 offset:2048
    v_mfma_f32_16x16x32_bf16 v[104:107], v[124:127], v[148:151], v[104:107]
    v_mfma_f32_16x16x32_bf16 v[108:111], v[124:127], v[152:155], v[108:111]
    s_waitcnt vmcnt(4)
    s_mul_i32 s58, s48, 3072
    v_add_u32 v30, s58, v25
    s_add_u32 s48, s48, 1
    s_cmp_eq_u32 s48, 14
    s_cselect_b32 s48, 0, s48
    s_waitcnt lgkmcnt(0)
    ds_read_b64_tr_b16 v[112:113], v16 offset:8192
    v_mfma_f32_16x16x32_bf16 v[64:67], v[128:131], v[156:159], v[64:67]
    ds_read_b64_tr_b16 v[114:115], v16 offset:8704
    v_mfma_f32_16x16x32_bf16 v[68:71], v[128:131], v[160:163], v[68:71]
    ds_read_b64_tr_b16 v[116:117], v17 offset:8192
    v_mfma_f32_16x16x32_bf16 v[72:75], v[128:131], v[164:167], v[72:75]
    ds_read_b64_tr_b16 v[118:119], v17 offset:8704
    v_mfma_f32_16x16x32_bf16 v[76:79], v[132:135], v[156:159], v[76:79]
    ds_read_b64_tr_b16 v[120:121], v18 offset:8192
    v_mfma_f32_16x16x32_bf16 v[80:83], v[132:135], v[160:163], v[80:83]
    ds_read_b64_tr_b16 v[122:123], v18 offset:8704
    v_mfma_f32_16x16x32_bf16 v[84:87], v[132:135], v[164:167], v[84:87]
    ds_read_b64_tr_b16 v[124:125], v19 offset:8192
    v_mfma_f32_16x16x32_bf16 v[88:91], v[136:139], v[156:159], v[88:91]
    ds_read_b64_tr_b16 v[126:127], v19 offset:8704
    v_mfma_f32_16x16x32_bf16 v[92:95], v[136:139], v[160:163], v[92:95]
    ds_read_b128 v[144:147], v30 offset:0
    v_mfma_f32_16x16x32_bf16 v[96:99], v[136:139], v[164:167], v[96:99]
    ds_read_b128 v[148:151], v30 offset:1024
    v_mfma_f32_16x16x32_bf16 v[100:103], v[140:143], v[156:159], v[100:103]
    ds_read_b128 v[152:155], v30 offset:2048
    v_mfma_f32_16x16x32_bf16 v[104:107], v[140:143], v[160:163], v[104:107]
    v_mfma_f32_16x16x32_bf16 v[108:111], v[140:143], v[164:167], v[108:111]
    s_mul_i32 s58, s49, 28672
    s_add_u32 s58, s58, s54
    s_add_u32 m0, s56, 0
    s_nop 0
    buffer_load_dwordx4 v8, s[36:39], s58 offen lds
    s_add_u32 m0, s56, 1024
    s_nop 0
    buffer_load_dwordx4 v9, s[36:39], s58 offen lds
    s_add_u32 m0, s56, 2048
    s_nop 0
    buffer_load_dwordx4 v10, s[36:39], s58 offen lds
    s_add_u32 m0, s56, 3072
    s_nop 0
    buffer_load_dwordx4 v11, s[36:39], s58 offen lds
    s_add_u32 m0, s56, 4096
    s_nop 0
    buffer_load_dwordx4 v12, s[36:39], s58 offen lds
    s_add_u32 m0, s56, 5120
    s_nop 0
    buffer_load_dwordx4 v13, s[36:39], s58 offen lds
    s_add_u32 m0, s56, 6144
    s_nop 0
    buffer_load_dwordx4 v14, s[36:39], s58 offen lds
    s_add_u32 s49, s49, 1
    s_cmp_eq_u32 s49, 8
    s_cselect_b32 s49, 0, s49
    s_waitcnt vmcnt(7)
    s_mul_i32 s58, s48, 3072
    v_add_u32 v31, s58, v25
    s_add_u32 s48, s48, 1
    s_cmp_eq_u32 s48, 14
    s_cselect_b32 s48, 0, s48
    s_waitcnt lgkmcnt(0)
    ds_read_b64_tr_b16 v[128:129], v16 offset:12288
    v_mfma_f32_16x16x32_bf16 v[64:67], v[112:115], v[144:147], v[64:67]
    ds_read_b64_tr_b16 v[130:131], v16 offset:12800
    v_mfma_f32_16x16x32_bf16 v[68:71], v[112:115], v[148:151], v[68:71]
    ds_read_b64_tr_b16 v[132:133], v17 offset:12288
    v_mfma_f32_16x16x32_bf16 v[72:75], v[112:115], v[152:155], v[72:75]
    ds_read_b64_tr_b16 v[134:135], v17 offset:12800
    v_mfma_f32_16x16x32_bf16 v[76:79], v[116:119], v[144:147], v[76:79]
    ds_read_b64_tr_b16 v[136:137], v18 offset:12288
    v_mfma_f32_16x16x32_bf16 v[80:83], v[116:119], v[148:151], v[80:83]
    ds_read_b64_tr_b16 v[138:139], v18 offset:12800
    v_mfma_f32_16x16x32_bf16 v[84:87], v[116:119], v[152:155], v[84:87]
    ds_read_b64_tr_b16 v[140:141], v19 offset:12288
    v_mfma_f32_16x16x32_bf16 v[88:91], v[120:123], v[144:147], v[88:91]
    ds_read_b64_tr_b16 v[142:143], v19 offset:12800
    v_mfma_f32_16x16x32_bf16 v[92:95], v[120:123], v[148:151], v[92:95]
    ds_read_b128 v[156:159], v31 offset:0
    v_mfma_f32_16x16x32_bf16 v[96:99], v[120:123], v[152:155], v[96:99]
    ds_read_b128 v[160:163], v31 offset:1024
    v_mfma_f32_16x16x32_bf16 v[100:103], v[124:127], v[144:147], v[100:103]
    ds_read_b128 v[164:167], v31 offset:2048
    v_mfma_f32_16x16x32_bf16 v[104:107], v[124:127], v[148:151], v[104:107]
    v_mfma_f32_16x16x32_bf16 v[108:111], v[124:127], v[152:155], v[108:111]
    s_waitcnt lgkmcnt(0)
    v_mfma_f32_16x16x32_bf16 v[64:67], v[128:131], v[156:159], v[64:67]
    v_mfma_f32_16x16x32_bf16 v[68:71], v[128:131], v[160:163], v[68:71]
    v_mfma_f32_16x16x32_bf16 v[72:75], v[128:131], v[164:167], v[72:75]
    v_mfma_f32_16x16x32_bf16 v[76:79], v[132:135], v[156:159], v[76:79]
    v_mfma_f32_16x16x32_bf16 v[80:83], v[132:135], v[160:163], v[80:83]
    v_mfma_f32_16x16x32_bf16 v[84:87], v[132:135], v[164:167], v[84:87]
    v_mfma_f32_16x16x32_bf16 v[88:91], v[136:139], v[156:159], v[88:91]
    v_mfma_f32_16x16x32_bf16 v[92:95], v[136:139], v[160:163], v[92:95]
    v_mfma_f32_16x16x32_bf16 v[96:99], v[136:139], v[164:167], v[96:99]
    v_mfma_f32_16x16x32_bf16 v[100:103], v[140:143], v[156:159], v[100:103]
    v_mfma_f32_16x16x32_bf16 v[104:107], v[140:143], v[160:163], v[104:107]
    v_mfma_f32_16x16x32_bf16 v[108:111], v[140:143], v[164:167], v[108:111]
    s_mul_i32 s58, s49, 28672
    s_add_u32 s58, s58, s54
    s_add_u32 m0, s56, 7168
    s_nop 0
    buffer_load_dwordx4 v8, s[36:39], s58 offen lds
    s_add_u32 m0, s56, 8192
    s_nop 0
    buffer_load_dwordx4 v9, s[36:39], s58 offen lds
    s_add_u32 m0, s56, 9216
    s_nop 0
    buffer_load_dwordx4 v10, s[36:39], s58 offen lds
    s_add_u32 m0, s56, 10240
    s_nop 0
    buffer_load_dwordx4 v11, s[36:39], s58 offen lds
    s_add_u32 m0, s56, 11264
    s_nop 0
    buffer_load_dwordx4 v12, s[36:39], s58 offen lds
    s_add_u32 m0, s56, 12288
    s_nop 0
    buffer_load_dwordx4 v13, s[36:39], s58 offen lds
    s_add_u32 m0, s56, 13312
    s_nop 0
    buffer_load_dwordx4 v14, s[36:39], s58 offen lds
    s_add_u32 s49, s49, 1
    s_cmp_eq_u32 s49, 8
    s_cselect_b32 s49, 0, s49
    s_mul_i32 s58, s49, 28672
    s_add_u32 s58, s58, s54
    s_add_u32 m0, s56, 14336
    s_nop 0
    buffer_load_dwordx4 v8, s[36:39], s58 offen lds
    s_add_u32 m0, s56, 15360
    s_nop 0
    buffer_load_dwordx4 v9, s[36:39], s58 offen lds
    s_add_u32 m0, s56, 16384
    s_nop 0
    buffer_load_dwordx4 v10, s[36:39], s58 offen lds
    s_add_u32 m0, s56, 17408
    s_nop 0
    buffer_load_dwordx4 v11, s[36:39], s58 offen lds
    s_add_u32 m0, s56, 18432
    s_nop 0
    buffer_load_dwordx4 v12, s[36:39], s58 offen lds
    s_add_u32 m0, s56, 19456
    s_nop 0
    buffer_load_dwordx4 v13, s[36:39], s58 offen lds
    s_add_u32 m0, s56, 20480
    s_nop 0
    buffer_load_dwordx4 v14, s[36:39], s58 offen lds
    s_add_u32 s49, s49, 1
    s_cmp_eq_u32 s49, 8
    s_cselect_b32 s49, 0, s49
    s_nop 7
    s_nop 1
    v_cvt_pk_bf16_f32 v168, v64, v65
    v_cvt_pk_bf16_f32 v169, v66, v67
    v_cvt_pk_bf16_f32 v170, v76, v77
    v_cvt_pk_bf16_f32 v171, v78, v79
    v_cvt_pk_bf16_f32 v172, v68, v69
    v_cvt_pk_bf16_f32 v173, v70, v71
    v_cvt_pk_bf16_f32 v174, v80, v81
    v_cvt_pk_bf16_f32 v175, v82, v83
    v_cvt_pk_bf16_f32 v176, v72, v73
    v_cvt_pk_bf16_f32 v177, v74, v75
    v_cvt_pk_bf16_f32 v178, v84, v85
    v_cvt_pk_bf16_f32 v179, v86, v87
    v_cvt_pk_bf16_f32 v180, v88, v89
    v_cvt_pk_bf16_f32 v181, v90, v91
    v_cvt_pk_bf16_f32 v182, v100, v101
    v_cvt_pk_bf16_f32 v183, v102, v103
    v_cvt_pk_bf16_f32 v184, v92, v93
    v_cvt_pk_bf16_f32 v185, v94, v95
    v_cvt_pk_bf16_f32 v186, v104, v105
    v_cvt_pk_bf16_f32 v187, v106, v107
    v_cvt_pk_bf16_f32 v188, v96, v97
    v_cvt_pk_bf16_f32 v189, v98, v99
    v_cvt_pk_bf16_f32 v190, v108, v109
    v_cvt_pk_bf16_f32 v191, v110, v111
    s_waitcnt vmcnt(63)
    s_nop 1
    v_mfma_f32_16x16x32_bf16 v[192:195], v[32:35], v[168:171], 0
    v_mfma_f32_16x16x32_bf16 v[196:199], v[32:35], v[172:175], 0
    v_mfma_f32_16x16x32_bf16 v[200:203], v[32:35], v[176:179], 0
    v_mfma_f32_16x16x32_bf16 v[204:207], v[40:43], v[168:171], 0
    v_mfma_f32_16x16x32_bf16 v[208:211], v[40:43], v[172:175], 0
    v_mfma_f32_16x16x32_bf16 v[212:215], v[40:43], v[176:179], 0
    v_mfma_f32_16x16x32_bf16 v[216:219], v[48:51], v[168:171], 0
    v_mfma_f32_16x16x32_bf16 v[220:223], v[48:51], v[172:175], 0
    v_mfma_f32_16x16x32_bf16 v[224:227], v[48:51], v[176:179], 0
    v_mfma_f32_16x16x32_bf16 v[192:195], v[36:39], v[180:183], v[192:195]
    v_mfma_f32_16x16x32_bf16 v[196:199], v[36:39], v[184:187], v[196:199]
    v_mfma_f32_16x16x32_bf16 v[200:203], v[36:39], v[188:191], v[200:203]
    v_mfma_f32_16x16x32_bf16 v[204:207], v[44:47], v[180:183], v[204:207]
    v_mfma_f32_16x16x32_bf16 v[208:211], v[44:47], v[184:187], v[208:211]
    v_mfma_f32_16x16x32_bf16 v[212:215], v[44:47], v[188:191], v[212:215]
    v_mfma_f32_16x16x32_bf16 v[216:219], v[52:55], v[180:183], v[216:219]
    v_mfma_f32_16x16x32_bf16 v[220:223], v[52:55], v[184:187], v[220:223]
    v_mfma_f32_16x16x32_bf16 v[224:227], v[52:55], v[188:191], v[224:227]
    s_barrier
    s_mul_i32 s58, s46, 9216
    v_add_u32 v28, s58, v25
    s_nop 7
    ds_write_b128 v28, v[192:195] offset:0
    ds_write_b128 v28, v[196:199] offset:1024
    ds_write_b128 v28, v[200:203] offset:2048
    ds_write_b128 v28, v[204:207] offset:3072
    ds_write_b128 v28, v[208:211] offset:4096
    ds_write_b128 v28, v[212:215] offset:5120
    ds_write_b128 v28, v[216:219] offset:6144
    ds_write_b128 v28, v[220:223] offset:7168
    ds_write_b128 v28, v[224:227] offset:8192
    s_waitcnt lgkmcnt(0)
    s_barrier
    s_cmp_ge_u32 s46, 3
    s_cbranch_scc1 K1_SMX_DONE
    s_lshl_b32 s58, s46, 10
    v_add_u32 v28, s58, v25
    ds_read_b128 v[64:67], v28 offset:0
    ds_read_b128 v[68:71], v28 offset:9216
    ds_read_b128 v[72:75], v28 offset:18432
    ds_read_b128 v[76:79], v28 offset:27648
    ds_read_b128 v[80:83], v28 offset:3072
    ds_read_b128 v[84:87], v28 offset:12288
    ds_read_b128 v[88:91], v28 offset:21504
    ds_read_b128 v[92:95], v28 offset:30720
    ds_read_b128 v[96:99], v28 offset:6144
    ds_read_b128 v[100:103], v28 offset:15360
    ds_read_b128 v[104:107], v28 offset:24576
    ds_read_b128 v[108:111], v28 offset:33792
    s_waitcnt lgkmcnt(0)
    v_add_f32 v64, v64, v68
    v_add_f32 v72, v72, v76
    v_add_f32 v65, v65, v69
    v_add_f32 v73, v73, v77
    v_add_f32 v66, v66, v70
    v_add_f32 v74, v74, v78
    v_add_f32 v67, v67, v71
    v_add_f32 v75, v75, v79
    v_add_f32 v64, v64, v72
    v_add_f32 v65, v65, v73
    v_add_f32 v66, v66, v74
    v_add_f32 v67, v67, v75
    v_add_f32 v80, v80, v84
    v_add_f32 v88, v88, v92
    v_add_f32 v81, v81, v85
    v_add_f32 v89, v89, v93
    v_add_f32 v82, v82, v86
    v_add_f32 v90, v90, v94
    v_add_f32 v83, v83, v87
    v_add_f32 v91, v91, v95
    v_add_f32 v80, v80, v88
    v_add_f32 v81, v81, v89
    v_add_f32 v82, v82, v90
    v_add_f32 v83, v83, v91
    v_add_f32 v96, v96, v100
    v_add_f32 v104, v104, v108
    v_add_f32 v97, v97, v101
    v_add_f32 v105, v105, v109
    v_add_f32 v98, v98, v102
    v_add_f32 v106, v106, v110
    v_add_f32 v99, v99, v103
    v_add_f32 v107, v107, v111
    v_add_f32 v96, v96, v104
    v_add_f32 v97, v97, v105
    v_add_f32 v98, v98, v106
    v_add_f32 v99, v99, v107
    v_max3_f32 v112, v64, v65, v66
    v_max3_f32 v112, v112, v67, v80
    v_max3_f32 v112, v112, v81, v82
    v_max3_f32 v112, v112, v83, v96
    v_max3_f32 v112, v112, v97, v98
    v_max_f32 v112, v112, v99
    v_mov_b32 v113, v112
    s_nop 1
    v_permlane16_swap_b32 v112, v113
    s_nop 1
    v_max_f32 v112, v112, v113
    v_mov_b32 v113, v112
    s_nop 1
    v_permlane32_swap_b32 v112, v113
    s_nop 1
    v_max_f32 v112, v112, v113
    v_mul_f32 v112, s61, v112
    v_fma_f32 v64, v64, s61, -v112
    v_fma_f32 v65, v65, s61, -v112
    v_fma_f32 v66, v66, s61, -v112
    v_fma_f32 v67, v67, s61, -v112
    v_fma_f32 v80, v80, s61, -v112
    v_fma_f32 v81, v81, s61, -v112
    v_fma_f32 v82, v82, s61, -v112
    v_fma_f32 v83, v83, s61, -v112
    v_fma_f32 v96, v96, s61, -v112
    v_fma_f32 v97, v97, s61, -v112
    v_fma_f32 v98, v98, s61, -v112
    v_fma_f32 v99, v99, s61, -v112
    v_exp_f32 v64, v64
    v_exp_f32 v65, v65
    v_exp_f32 v66, v66
    v_exp_f32 v67, v67
    v_exp_f32 v80, v80
    v_exp_f32 v81, v81
    v_exp_f32 v82, v82
    v_exp_f32 v83, v83
    v_exp_f32 v96, v96
    v_exp_f32 v97, v97
    v_exp_f32 v98, v98
    v_exp_f32 v99, v99
    s_nop 0
    v_add_f32 v114, v64, v65
    v_add_f32 v114, v114, v66
    v_add_f32 v114, v114, v67
    v_add_f32 v114, v114, v80
    v_add_f32 v114, v114, v81
    v_add_f32 v114, v114, v82
    v_add_f32 v114, v114, v83
    v_add_f32 v114, v114, v96
    v_add_f32 v114, v114, v97
    v_add_f32 v114, v114, v98
    v_add_f32 v114, v114, v99
    v_mov_b32 v113, v114
    s_nop 1
    v_permlane16_swap_b32 v114, v113
    s_nop 1
    v_add_f32 v114, v114, v113
    v_mov_b32 v113, v114
    s_nop 1
    v_permlane32_swap_b32 v114, v113
    s_nop 1
    v_add_f32 v114, v114, v113
    v_rcp_f32 v114, v114
    s_nop 0
    v_mul_f32 v64, v64, v114
    v_mul_f32 v65, v65, v114
    v_mul_f32 v66, v66, v114
    v_mul_f32 v67, v67, v114
    v_mul_f32 v80, v80, v114
    v_mul_f32 v81, v81, v114
    v_mul_f32 v82, v82, v114
    v_mul_f32 v83, v83, v114
    v_mul_f32 v96, v96, v114
    v_mul_f32 v97, v97, v114
    v_mul_f32 v98, v98, v114
    v_mul_f32 v99, v99, v114
    v_cvt_pk_bf16_f32 v116, v64, v65
    v_cvt_pk_bf16_f32 v117, v66, v67
    v_cvt_pk_bf16_f32 v118, v80, v81
    v_cvt_pk_bf16_f32 v119, v82, v83
    v_cvt_pk_bf16_f32 v120, v96, v97
    v_cvt_pk_bf16_f32 v121, v98, v99
    s_mul_i32 s58, s46, 1536
    v_add_u32 v28, s58, v26
    ds_write_b64 v28, v[116:117] offset:36864
    ds_write_b64 v28, v[118:119] offset:37376
    ds_write_b64 v28, v[120:121] offset:37888
    s_waitcnt lgkmcnt(0)
K1_SMX_DONE:
    s_barrier
    ds_read_b64 v[168:169], v26 offset:36864
    ds_read_b64 v[170:171], v26 offset:37376
    ds_read_b64 v[172:173], v26 offset:37888
    v_mov_b32 v174, 0
    v_mov_b32 v175, 0
    ds_read_b64 v[176:177], v26 offset:38400
    ds_read_b64 v[178:179], v26 offset:38912
    ds_read_b64 v[180:181], v26 offset:39424
    v_mov_b32 v182, 0
    v_mov_b32 v183, 0
    ds_read_b64 v[184:185], v26 offset:39936
    ds_read_b64 v[186:187], v26 offset:40448
    ds_read_b64 v[188:189], v26 offset:40960
    v_mov_b32 v190, 0
    v_mov_b32 v191, 0
    s_waitcnt vmcnt(57)
    ds_read_b64_tr_b16 v[112:113], v20 offset:0
    ds_read_b64_tr_b16 v[114:115], v20 offset:2048
    ds_read_b64_tr_b16 v[116:117], v20 offset:4096
    v_mov_b32 v118, 0
    v_mov_b32 v119, 0
    ds_read_b64_tr_b16 v[120:121], v21 offset:0
    ds_read_b64_tr_b16 v[122:123], v21 offset:2048
    ds_read_b64_tr_b16 v[124:125], v21 offset:4096
    v_mov_b32 v126, 0
    v_mov_b32 v127, 0
    ds_read_b64_tr_b16 v[128:129], v22 offset:0
    ds_read_b64_tr_b16 v[130:131], v22 offset:2048
    ds_read_b64_tr_b16 v[132:133], v22 offset:4096
    v_mov_b32 v134, 0
    v_mov_b32 v135, 0
    ds_read_b64_tr_b16 v[136:137], v23 offset:0
    ds_read_b64_tr_b16 v[138:139], v23 offset:2048
    ds_read_b64_tr_b16 v[140:141], v23 offset:4096
    v_mov_b32 v142, 0
    v_mov_b32 v143, 0
    s_waitcnt lgkmcnt(0)
    v_mfma_f32_16x16x32_bf16 v[64:67], v[112:115], v[168:171], 0
    v_mfma_f32_16x16x32_bf16 v[68:71], v[112:115], v[176:179], 0
    v_mfma_f32_16x16x32_bf16 v[72:75], v[112:115], v[184:187], 0
    v_mfma_f32_16x16x32_bf16 v[76:79], v[120:123], v[168:171], 0
    v_mfma_f32_16x16x32_bf16 v[80:83], v[120:123], v[176:179], 0
    v_mfma_f32_16x16x32_bf16 v[84:87], v[120:123], v[184:187], 0
    v_mfma_f32_16x16x32_bf16 v[88:91], v[128:131], v[168:171], 0
    v_mfma_f32_16x16x32_bf16 v[92:95], v[128:131], v[176:179], 0
    v_mfma_f32_16x16x32_bf16 v[96:99], v[128:131], v[184:187], 0
    v_mfma_f32_16x16x32_bf16 v[100:103], v[136:139], v[168:171], 0
    v_mfma_f32_16x16x32_bf16 v[104:107], v[136:139], v[176:179], 0
    v_mfma_f32_16x16x32_bf16 v[108:111], v[136:139], v[184:187], 0
    v_mfma_f32_16x16x32_bf16 v[64:67], v[116:119], v[172:175], v[64:67]
    v_mfma_f32_16x16x32_bf16 v[68:71], v[116:119], v[180:183], v[68:71]
    v_mfma_f32_16x16x32_bf16 v[72:75], v[116:119], v[188:191], v[72:75]
    v_mfma_f32_16x16x32_bf16 v[76:79], v[124:127], v[172:175], v[76:79]
    v_mfma_f32_16x16x32_bf16 v[80:83], v[124:127], v[180:183], v[80:83]
    v_mfma_f32_16x16x32_bf16 v[84:87], v[124:127], v[188:191], v[84:87]
    v_mfma_f32_16x16x32_bf16 v[88:91], v[132:135], v[172:175], v[88:91]
    v_mfma_f32_16x16x32_bf16 v[92:95], v[132:135], v[180:183], v[92:95]
    v_mfma_f32_16x16x32_bf16 v[96:99], v[132:135], v[188:191], v[96:99]
    v_mfma_f32_16x16x32_bf16 v[100:103], v[140:143], v[172:175], v[100:103]
    v_mfma_f32_16x16x32_bf16 v[104:107], v[140:143], v[180:183], v[104:107]
    v_mfma_f32_16x16x32_bf16 v[108:111], v[140:143], v[188:191], v[108:111]
    s_nop 7
    s_nop 1
    v_cvt_pk_bf16_f32 v192, v64, v65
    v_cvt_pk_bf16_f32 v193, v66, v67
    v_cvt_pk_bf16_f32 v194, v76, v77
    v_cvt_pk_bf16_f32 v195, v78, v79
    v_cvt_pk_bf16_f32 v196, v68, v69
    v_cvt_pk_bf16_f32 v197, v70, v71
    v_cvt_pk_bf16_f32 v198, v80, v81
    v_cvt_pk_bf16_f32 v199, v82, v83
    v_cvt_pk_bf16_f32 v200, v72, v73
    v_cvt_pk_bf16_f32 v201, v74, v75
    v_cvt_pk_bf16_f32 v202, v84, v85
    v_cvt_pk_bf16_f32 v203, v86, v87
    v_cvt_pk_bf16_f32 v204, v88, v89
    v_cvt_pk_bf16_f32 v205, v90, v91
    v_cvt_pk_bf16_f32 v206, v100, v101
    v_cvt_pk_bf16_f32 v207, v102, v103
    v_cvt_pk_bf16_f32 v208, v92, v93
    v_cvt_pk_bf16_f32 v209, v94, v95
    v_cvt_pk_bf16_f32 v210, v104, v105
    v_cvt_pk_bf16_f32 v211, v106, v107
    v_cvt_pk_bf16_f32 v212, v96, v97
    v_cvt_pk_bf16_f32 v213, v98, v99
    v_cvt_pk_bf16_f32 v214, v108, v109
    v_cvt_pk_bf16_f32 v215, v110, v111
    s_mul_i32 s58, s46, 6144
    v_add_u32 v28, s58, v25
    ds_write_b128 v28, v[192:195] offset:0
    ds_write_b128 v28, v[196:199] offset:1024
    ds_write_b128 v28, v[200:203] offset:2048
    ds_write_b128 v28, v[204:207] offset:3072
    ds_write_b128 v28, v[208:211] offset:4096
    ds_write_b128 v28, v[212:215] offset:5120
    s_waitcnt lgkmcnt(0)
    s_barrier
    v_add_u32 v29, s56, v25
    s_waitcnt vmcnt(14)
    s_add_u32 s58, s3, 0
    s_and_b32 s58, s58, 7
    s_mul_i32 s58, s58, 3072
    v_add_u32 v30, s58, v25
    ds_read_b64_tr_b16 v[148:149], v24 offset:0
    ds_read_b64_tr_b16 v[150:151], v24 offset:3584
    ds_read_b64_tr_b16 v[152:153], v24 offset:32
    ds_read_b64_tr_b16 v[154:155], v24 offset:3616
    ds_read_b64_tr_b16 v[156:157], v24 offset:64
    ds_read_b64_tr_b16 v[158:159], v24 offset:3648
    ds_read_b64_tr_b16 v[160:161], v24 offset:96
    ds_read_b64_tr_b16 v[162:163], v24 offset:3680
    ds_read_b64_tr_b16 v[164:165], v24 offset:128
    ds_read_b64_tr_b16 v[166:167], v24 offset:3712
    ds_read_b64_tr_b16 v[168:169], v24 offset:160
    ds_read_b64_tr_b16 v[170:171], v24 offset:3744
    ds_read_b64_tr_b16 v[172:173], v24 offset:192
    ds_read_b64_tr_b16 v[174:175], v24 offset:3776
    ds_read_b128 v[204:207], v30 offset:0
    ds_read_b128 v[208:211], v30 offset:1024
    ds_read_b128 v[212:215], v30 offset:2048
    s_waitcnt vmcnt(7)
    s_add_u32 s58, s3, 1
    s_and_b32 s58, s58, 7
    s_mul_i32 s58, s58, 3072
    v_add_u32 v31, s58, v25
    s_waitcnt lgkmcnt(0)
    ds_read_b64_tr_b16 v[176:177], v24 offset:7168
    v_mfma_f32_16x16x32_bf16 v[64:67], v[148:151], v[204:207], 0
    ds_read_b64_tr_b16 v[178:179], v24 offset:10752
    v_mfma_f32_16x16x32_bf16 v[68:71], v[148:151], v[208:211], 0
    ds_read_b64_tr_b16 v[180:181], v24 offset:7200
    v_mfma_f32_16x16x32_bf16 v[72:75], v[148:151], v[212:215], 0
    ds_read_b64_tr_b16 v[182:183], v24 offset:10784
    v_mfma_f32_16x16x32_bf16 v[76:79], v[152:155], v[204:207], 0
    ds_read_b64_tr_b16 v[184:185], v24 offset:7232
    v_mfma_f32_16x16x32_bf16 v[80:83], v[152:155], v[208:211], 0
    ds_read_b64_tr_b16 v[186:187], v24 offset:10816
    v_mfma_f32_16x16x32_bf16 v[84:87], v[152:155], v[212:215], 0
    ds_read_b64_tr_b16 v[188:189], v24 offset:7264
    v_mfma_f32_16x16x32_bf16 v[88:91], v[156:159], v[204:207], 0
    ds_read_b64_tr_b16 v[190:191], v24 offset:10848
    v_mfma_f32_16x16x32_bf16 v[92:95], v[156:159], v[208:211], 0
    ds_read_b64_tr_b16 v[192:193], v24 offset:7296
    v_mfma_f32_16x16x32_bf16 v[96:99], v[156:159], v[212:215], 0
    ds_read_b64_tr_b16 v[194:195], v24 offset:10880
    v_mfma_f32_16x16x32_bf16 v[100:103], v[160:163], v[204:207], 0
    ds_read_b64_tr_b16 v[196:197], v24 offset:7328
    v_mfma_f32_16x16x32_bf16 v[104:107], v[160:163], v[208:211], 0
    ds_read_b64_tr_b16 v[198:199], v24 offset:10912
    v_mfma_f32_16x16x32_bf16 v[108:111], v[160:163], v[212:215], 0
    ds_read_b64_tr_b16 v[200:201], v24 offset:7360
    v_mfma_f32_16x16x32_bf16 v[112:115], v[164:167], v[204:207], 0
    ds_read_b64_tr_b16 v[202:203], v24 offset:10944
    v_mfma_f32_16x16x32_bf16 v[116:119], v[164:167], v[208:211], 0
    ds_read_b128 v[216:219], v31 offset:0
    v_mfma_f32_16x16x32_bf16 v[120:123], v[164:167], v[212:215], 0
    ds_read_b128 v[220:223], v31 offset:1024
    v_mfma_f32_16x16x32_bf16 v[124:127], v[168:171], v[204:207], 0
    ds_read_b128 v[224:227], v31 offset:2048
    v_mfma_f32_16x16x32_bf16 v[128:131], v[168:171], v[208:211], 0
    v_mfma_f32_16x16x32_bf16 v[132:135], v[168:171], v[212:215], 0
    v_mfma_f32_16x16x32_bf16 v[136:139], v[172:175], v[204:207], 0
    v_mfma_f32_16x16x32_bf16 v[140:143], v[172:175], v[208:211], 0
    v_mfma_f32_16x16x32_bf16 v[144:147], v[172:175], v[212:215], 0
    s_mul_i32 s58, s49, 28672
    s_add_u32 s58, s58, s54
    s_add_u32 m0, s56, 0
    s_nop 0
    buffer_load_dwordx4 v8, s[36:39], s58 offen lds
    s_add_u32 m0, s56, 1024
    s_nop 0
    buffer_load_dwordx4 v9, s[36:39], s58 offen lds
    s_add_u32 m0, s56, 2048
    s_nop 0
    buffer_load_dwordx4 v10, s[36:39], s58 offen lds
    s_add_u32 m0, s56, 3072
    s_nop 0
    buffer_load_dwordx4 v11, s[36:39], s58 offen lds
    s_add_u32 m0, s56, 4096
    s_nop 0
    buffer_load_dwordx4 v12, s[36:39], s58 offen lds
    s_add_u32 m0, s56, 5120
    s_nop 0
    buffer_load_dwordx4 v13, s[36:39], s58 offen lds
    s_add_u32 m0, s56, 6144
    s_nop 0
    buffer_load_dwordx4 v14, s[36:39], s58 offen lds
    s_add_u32 s49, s49, 1
    s_cmp_eq_u32 s49, 8
    s_cselect_b32 s49, 0, s49
    s_waitcnt vmcnt(7)
    s_add_u32 s58, s3, 2
    s_and_b32 s58, s58, 7
    s_mul_i32 s58, s58, 3072
    v_add_u32 v30, s58, v25
    s_waitcnt lgkmcnt(0)
    ds_read_b64_tr_b16 v[148:149], v24 offset:14336
    v_mfma_f32_16x16x32_bf16 v[64:67], v[176:179], v[216:219], v[64:67]
    ds_read_b64_tr_b16 v[150:151], v24 offset:17920
    v_mfma_f32_16x16x32_bf16 v[68:71], v[176:179], v[220:223], v[68:71]
    ds_read_b64_tr_b16 v[152:153], v24 offset:14368
    v_mfma_f32_16x16x32_bf16 v[72:75], v[176:179], v[224:227], v[72:75]
    ds_read_b64_tr_b16 v[154:155], v24 offset:17952
    v_mfma_f32_16x16x32_bf16 v[76:79], v[180:183], v[216:219], v[76:79]
    ds_read_b64_tr_b16 v[156:157], v24 offset:14400
    v_mfma_f32_16x16x32_bf16 v[80:83], v[180:183], v[220:223], v[80:83]
    ds_read_b64_tr_b16 v[158:159], v24 offset:17984
    v_mfma_f32_16x16x32_bf16 v[84:87], v[180:183], v[224:227], v[84:87]
    ds_read_b64_tr_b16 v[160:161], v24 offset:14432
    v_mfma_f32_16x16x32_bf16 v[88:91], v[184:187], v[216:219], v[88:91]
    ds_read_b64_tr_b16 v[162:163], v24 offset:18016
    v_mfma_f32_16x16x32_bf16 v[92:95], v[184:187], v[220:223], v[92:95]
    ds_read_b64_tr_b16 v[164:165], v24 offset:14464
    v_mfma_f32_16x16x32_bf16 v[96:99], v[184:187], v[224:227], v[96:99]
    ds_read_b64_tr_b16 v[166:167], v24 offset:18048
    v_mfma_f32_16x16x32_bf16 v[100:103], v[188:191], v[216:219], v[100:103]
    ds_read_b64_tr_b16 v[168:169], v24 offset:14496
    v_mfma_f32_16x16x32_bf16 v[104:107], v[188:191], v[220:223], v[104:107]
    ds_read_b64_tr_b16 v[170:171], v24 offset:18080
    v_mfma_f32_16x16x32_bf16 v[108:111], v[188:191], v[224:227], v[108:111]
    ds_read_b64_tr_b16 v[172:173], v24 offset:14528
    v_mfma_f32_16x16x32_bf16 v[112:115], v[192:195], v[216:219], v[112:115]
    ds_read_b64_tr_b16 v[174:175], v24 offset:18112
    v_mfma_f32_16x16x32_bf16 v[116:119], v[192:195], v[220:223], v[116:119]
    ds_read_b128 v[204:207], v30 offset:0
    v_mfma_f32_16x16x32_bf16 v[120:123], v[192:195], v[224:227], v[120:123]
    ds_read_b128 v[208:211], v30 offset:1024
    v_mfma_f32_16x16x32_bf16 v[124:127], v[196:199], v[216:219], v[124:127]
    ds_read_b128 v[212:215], v30 offset:2048
    v_mfma_f32_16x16x32_bf16 v[128:131], v[196:199], v[220:223], v[128:131]
    v_mfma_f32_16x16x32_bf16 v[132:135], v[196:199], v[224:227], v[132:135]
    v_mfma_f32_16x16x32_bf16 v[136:139], v[200:203], v[216:219], v[136:139]
    v_mfma_f32_16x16x32_bf16 v[140:143], v[200:203], v[220:223], v[140:143]
    v_mfma_f32_16x16x32_bf16 v[144:147], v[200:203], v[224:227], v[144:147]
    s_mul_i32 s58, s49, 28672
    s_add_u32 s58, s58, s54
    s_add_u32 m0, s56, 7168
    s_nop 0
    buffer_load_dwordx4 v8, s[36:39], s58 offen lds
    s_add_u32 m0, s56, 8192
    s_nop 0
    buffer_load_dwordx4 v9, s[36:39], s58 offen lds
    s_add_u32 m0, s56, 9216
    s_nop 0
    buffer_load_dwordx4 v10, s[36:39], s58 offen lds
    s_add_u32 m0, s56, 10240
    s_nop 0
    buffer_load_dwordx4 v11, s[36:39], s58 offen lds
    s_add_u32 m0, s56, 11264
    s_nop 0
    buffer_load_dwordx4 v12, s[36:39], s58 offen lds
    s_add_u32 m0, s56, 12288
    s_nop 0
    buffer_load_dwordx4 v13, s[36:39], s58 offen lds
    s_add_u32 m0, s56, 13312
    s_nop 0
    buffer_load_dwordx4 v14, s[36:39], s58 offen lds
    s_add_u32 s49, s49, 1
    s_cmp_eq_u32 s49, 8
    s_cselect_b32 s49, 0, s49
    s_waitcnt vmcnt(7)
    s_add_u32 s58, s3, 3
    s_and_b32 s58, s58, 7
    s_mul_i32 s58, s58, 3072
    v_add_u32 v31, s58, v25
    s_waitcnt lgkmcnt(0)
    ds_read_b64_tr_b16 v[176:177], v24 offset:0
    v_mfma_f32_16x16x32_bf16 v[64:67], v[148:151], v[204:207], v[64:67]
    ds_read_b64_tr_b16 v[178:179], v24 offset:3584
    v_mfma_f32_16x16x32_bf16 v[68:71], v[148:151], v[208:211], v[68:71]
    ds_read_b64_tr_b16 v[180:181], v24 offset:32
    v_mfma_f32_16x16x32_bf16 v[72:75], v[148:151], v[212:215], v[72:75]
    ds_read_b64_tr_b16 v[182:183], v24 offset:3616
    v_mfma_f32_16x16x32_bf16 v[76:79], v[152:155], v[204:207], v[76:79]
    ds_read_b64_tr_b16 v[184:185], v24 offset:64
    v_mfma_f32_16x16x32_bf16 v[80:83], v[152:155], v[208:211], v[80:83]
    ds_read_b64_tr_b16 v[186:187], v24 offset:3648
    v_mfma_f32_16x16x32_bf16 v[84:87], v[152:155], v[212:215], v[84:87]
    ds_read_b64_tr_b16 v[188:189], v24 offset:96
    v_mfma_f32_16x16x32_bf16 v[88:91], v[156:159], v[204:207], v[88:91]
    ds_read_b64_tr_b16 v[190:191], v24 offset:3680
    v_mfma_f32_16x16x32_bf16 v[92:95], v[156:159], v[208:211], v[92:95]
    ds_read_b64_tr_b16 v[192:193], v24 offset:128
    v_mfma_f32_16x16x32_bf16 v[96:99], v[156:159], v[212:215], v[96:99]
    ds_read_b64_tr_b16 v[194:195], v24 offset:3712
    v_mfma_f32_16x16x32_bf16 v[100:103], v[160:163], v[204:207], v[100:103]
    ds_read_b64_tr_b16 v[196:197], v24 offset:160
    v_mfma_f32_16x16x32_bf16 v[104:107], v[160:163], v[208:211], v[104:107]
    ds_read_b64_tr_b16 v[198:199], v24 offset:3744
    v_mfma_f32_16x16x32_bf16 v[108:111], v[160:163], v[212:215], v[108:111]
    ds_read_b64_tr_b16 v[200:201], v24 offset:192
    v_mfma_f32_16x16x32_bf16 v[112:115], v[164:167], v[204:207], v[112:115]
    ds_read_b64_tr_b16 v[202:203], v24 offset:3776
    v_mfma_f32_16x16x32_bf16 v[116:119], v[164:167], v[208:211], v[116:119]
    ds_read_b128 v[216:219], v31 offset:0
    v_mfma_f32_16x16x32_bf16 v[120:123], v[164:167], v[212:215], v[120:123]
    ds_read_b128 v[220:223], v31 offset:1024
    v_mfma_f32_16x16x32_bf16 v[124:127], v[168:171], v[204:207], v[124:127]
    ds_read_b128 v[224:227], v31 offset:2048
    v_mfma_f32_16x16x32_bf16 v[128:131], v[168:171], v[208:211], v[128:131]
    v_mfma_f32_16x16x32_bf16 v[132:135], v[168:171], v[212:215], v[132:135]
    v_mfma_f32_16x16x32_bf16 v[136:139], v[172:175], v[204:207], v[136:139]
    v_mfma_f32_16x16x32_bf16 v[140:143], v[172:175], v[208:211], v[140:143]
    v_mfma_f32_16x16x32_bf16 v[144:147], v[172:175], v[212:215], v[144:147]
    s_mul_i32 s58, s49, 28672
    s_add_u32 s58, s58, s54
    s_add_u32 m0, s56, 14336
    s_nop 0
    buffer_load_dwordx4 v8, s[36:39], s58 offen lds
    s_add_u32 m0, s56, 15360
    s_nop 0
    buffer_load_dwordx4 v9, s[36:39], s58 offen lds
    s_add_u32 m0, s56, 16384
    s_nop 0
    buffer_load_dwordx4 v10, s[36:39], s58 offen lds
    s_add_u32 m0, s56, 17408
    s_nop 0
    buffer_load_dwordx4 v11, s[36:39], s58 offen lds
    s_add_u32 m0, s56, 18432
    s_nop 0
    buffer_load_dwordx4 v12, s[36:39], s58 offen lds
    s_add_u32 m0, s56, 19456
    s_nop 0
    buffer_load_dwordx4 v13, s[36:39], s58 offen lds
    s_add_u32 m0, s56, 20480
    s_nop 0
    buffer_load_dwordx4 v14, s[36:39], s58 offen lds
    s_add_u32 s49, s49, 1
    s_cmp_eq_u32 s49, 8
    s_cselect_b32 s49, 0, s49
    s_waitcnt vmcnt(7)
    s_add_u32 s58, s3, 4
    s_and_b32 s58, s58, 7
    s_mul_i32 s58, s58, 3072
    v_add_u32 v30, s58, v25
    s_waitcnt lgkmcnt(0)
    ds_read_b64_tr_b16 v[148:149], v24 offset:7168
    v_mfma_f32_16x16x32_bf16 v[64:67], v[176:179], v[216:219], v[64:67]
    ds_read_b64_tr_b16 v[150:151], v24 offset:10752
    v_mfma_f32_16x16x32_bf16 v[68:71], v[176:179], v[220:223], v[68:71]
    ds_read_b64_tr_b16 v[152:153], v24 offset:7200
    v_mfma_f32_16x16x32_bf16 v[72:75], v[176:179], v[224:227], v[72:75]
    ds_read_b64_tr_b16 v[154:155], v24 offset:10784
    v_mfma_f32_16x16x32_bf16 v[76:79], v[180:183], v[216:219], v[76:79]
    ds_read_b64_tr_b16 v[156:157], v24 offset:7232
    v_mfma_f32_16x16x32_bf16 v[80:83], v[180:183], v[220:223], v[80:83]
    ds_read_b64_tr_b16 v[158:159], v24 offset:10816
    v_mfma_f32_16x16x32_bf16 v[84:87], v[180:183], v[224:227], v[84:87]
    ds_read_b64_tr_b16 v[160:161], v24 offset:7264
    v_mfma_f32_16x16x32_bf16 v[88:91], v[184:187], v[216:219], v[88:91]
    ds_read_b64_tr_b16 v[162:163], v24 offset:10848
    v_mfma_f32_16x16x32_bf16 v[92:95], v[184:187], v[220:223], v[92:95]
    ds_read_b64_tr_b16 v[164:165], v24 offset:7296
    v_mfma_f32_16x16x32_bf16 v[96:99], v[184:187], v[224:227], v[96:99]
    ds_read_b64_tr_b16 v[166:167], v24 offset:10880
    v_mfma_f32_16x16x32_bf16 v[100:103], v[188:191], v[216:219], v[100:103]
    ds_read_b64_tr_b16 v[168:169], v24 offset:7328
    v_mfma_f32_16x16x32_bf16 v[104:107], v[188:191], v[220:223], v[104:107]
    ds_read_b64_tr_b16 v[170:171], v24 offset:10912
    v_mfma_f32_16x16x32_bf16 v[108:111], v[188:191], v[224:227], v[108:111]
    ds_read_b64_tr_b16 v[172:173], v24 offset:7360
    v_mfma_f32_16x16x32_bf16 v[112:115], v[192:195], v[216:219], v[112:115]
    ds_read_b64_tr_b16 v[174:175], v24 offset:10944
    v_mfma_f32_16x16x32_bf16 v[116:119], v[192:195], v[220:223], v[116:119]
    ds_read_b128 v[204:207], v30 offset:0
    v_mfma_f32_16x16x32_bf16 v[120:123], v[192:195], v[224:227], v[120:123]
    ds_read_b128 v[208:211], v30 offset:1024
    v_mfma_f32_16x16x32_bf16 v[124:127], v[196:199], v[216:219], v[124:127]
    ds_read_b128 v[212:215], v30 offset:2048
    v_mfma_f32_16x16x32_bf16 v[128:131], v[196:199], v[220:223], v[128:131]
    v_mfma_f32_16x16x32_bf16 v[132:135], v[196:199], v[224:227], v[132:135]
    v_mfma_f32_16x16x32_bf16 v[136:139], v[200:203], v[216:219], v[136:139]
    v_mfma_f32_16x16x32_bf16 v[140:143], v[200:203], v[220:223], v[140:143]
    v_mfma_f32_16x16x32_bf16 v[144:147], v[200:203], v[224:227], v[144:147]
    s_mul_i32 s58, s49, 28672
    s_add_u32 s58, s58, s54
    s_add_u32 m0, s56, 0
    s_nop 0
    buffer_load_dwordx4 v8, s[36:39], s58 offen lds
    s_add_u32 m0, s56, 1024
    s_nop 0
    buffer_load_dwordx4 v9, s[36:39], s58 offen lds
    s_add_u32 m0, s56, 2048
    s_nop 0
    buffer_load_dwordx4 v10, s[36:39], s58 offen lds
    s_add_u32 m0, s56, 3072
    s_nop 0
    buffer_load_dwordx4 v11, s[36:39], s58 offen lds
    s_add_u32 m0, s56, 4096
    s_nop 0
    buffer_load_dwordx4 v12, s[36:39], s58 offen lds
    s_add_u32 m0, s56, 5120
    s_nop 0
    buffer_load_dwordx4 v13, s[36:39], s58 offen lds
    s_add_u32 m0, s56, 6144
    s_nop 0
    buffer_load_dwordx4 v14, s[36:39], s58 offen lds
    s_add_u32 s49, s49, 1
    s_cmp_eq_u32 s49, 8
    s_cselect_b32 s49, 0, s49
    s_waitcnt vmcnt(7)
    s_add_u32 s58, s3, 5
    s_and_b32 s58, s58, 7
    s_mul_i32 s58, s58, 3072
    v_add_u32 v31, s58, v25
    s_waitcnt lgkmcnt(0)
    ds_read_b64_tr_b16 v[176:177], v24 offset:14336
    v_mfma_f32_16x16x32_bf16 v[64:67], v[148:151], v[204:207], v[64:67]
    ds_read_b64_tr_b16 v[178:179], v24 offset:17920
    v_mfma_f32_16x16x32_bf16 v[68:71], v[148:151], v[208:211], v[68:71]
    ds_read_b64_tr_b16 v[180:181], v24 offset:14368
    v_mfma_f32_16x16x32_bf16 v[72:75], v[148:151], v[212:215], v[72:75]
    ds_read_b64_tr_b16 v[182:183], v24 offset:17952
    v_mfma_f32_16x16x32_bf16 v[76:79], v[152:155], v[204:207], v[76:79]
    ds_read_b64_tr_b16 v[184:185], v24 offset:14400
    v_mfma_f32_16x16x32_bf16 v[80:83], v[152:155], v[208:211], v[80:83]
    ds_read_b64_tr_b16 v[186:187], v24 offset:17984
    v_mfma_f32_16x16x32_bf16 v[84:87], v[152:155], v[212:215], v[84:87]
    ds_read_b64_tr_b16 v[188:189], v24 offset:14432
    v_mfma_f32_16x16x32_bf16 v[88:91], v[156:159], v[204:207], v[88:91]
    ds_read_b64_tr_b16 v[190:191], v24 offset:18016
    v_mfma_f32_16x16x32_bf16 v[92:95], v[156:159], v[208:211], v[92:95]
    ds_read_b64_tr_b16 v[192:193], v24 offset:14464
    v_mfma_f32_16x16x32_bf16 v[96:99], v[156:159], v[212:215], v[96:99]
    ds_read_b64_tr_b16 v[194:195], v24 offset:18048
    v_mfma_f32_16x16x32_bf16 v[100:103], v[160:163], v[204:207], v[100:103]
    ds_read_b64_tr_b16 v[196:197], v24 offset:14496
    v_mfma_f32_16x16x32_bf16 v[104:107], v[160:163], v[208:211], v[104:107]
    ds_read_b64_tr_b16 v[198:199], v24 offset:18080
    v_mfma_f32_16x16x32_bf16 v[108:111], v[160:163], v[212:215], v[108:111]
    ds_read_b64_tr_b16 v[200:201], v24 offset:14528
    v_mfma_f32_16x16x32_bf16 v[112:115], v[164:167], v[204:207], v[112:115]
    ds_read_b64_tr_b16 v[202:203], v24 offset:18112
    v_mfma_f32_16x16x32_bf16 v[116:119], v[164:167], v[208:211], v[116:119]
    ds_read_b128 v[216:219], v31 offset:0
    v_mfma_f32_16x16x32_bf16 v[120:123], v[164:167], v[212:215], v[120:123]
    ds_read_b128 v[220:223], v31 offset:1024
    v_mfma_f32_16x16x32_bf16 v[124:127], v[168:171], v[204:207], v[124:127]
    ds_read_b128 v[224:227], v31 offset:2048
    v_mfma_f32_16x16x32_bf16 v[128:131], v[168:171], v[208:211], v[128:131]
    v_mfma_f32_16x16x32_bf16 v[132:135], v[168:171], v[212:215], v[132:135]
    v_mfma_f32_16x16x32_bf16 v[136:139], v[172:175], v[204:207], v[136:139]
    v_mfma_f32_16x16x32_bf16 v[140:143], v[172:175], v[208:211], v[140:143]
    v_mfma_f32_16x16x32_bf16 v[144:147], v[172:175], v[212:215], v[144:147]
    s_mul_i32 s58, s49, 28672
    s_add_u32 s58, s58, s54
    s_add_u32 m0, s56, 7168
    s_nop 0
    buffer_load_dwordx4 v8, s[36:39], s58 offen lds
    s_add_u32 m0, s56, 8192
    s_nop 0
    buffer_load_dwordx4 v9, s[36:39], s58 offen lds
    s_add_u32 m0, s56, 9216
    s_nop 0
    buffer_load_dwordx4 v10, s[36:39], s58 offen lds
    s_add_u32 m0, s56, 10240
    s_nop 0
    buffer_load_dwordx4 v11, s[36:39], s58 offen lds
    s_add_u32 m0, s56, 11264
    s_nop 0
    buffer_load_dwordx4 v12, s[36:39], s58 offen lds
    s_add_u32 m0, s56, 12288
    s_nop 0
    buffer_load_dwordx4 v13, s[36:39], s58 offen lds
    s_add_u32 m0, s56, 13312
    s_nop 0
    buffer_load_dwordx4 v14, s[36:39], s58 offen lds
    s_add_u32 s49, s49, 1
    s_cmp_eq_u32 s49, 8
    s_cselect_b32 s49, 0, s49
    s_waitcnt vmcnt(7)
    s_add_u32 s58, s3, 6
    s_and_b32 s58, s58, 7
    s_mul_i32 s58, s58, 3072
    v_add_u32 v30, s58, v25
    s_waitcnt lgkmcnt(0)
    ds_read_b64_tr_b16 v[148:149], v24 offset:0
    v_mfma_f32_16x16x32_bf16 v[64:67], v[176:179], v[216:219], v[64:67]
    ds_read_b64_tr_b16 v[150:151], v24 offset:3584
    v_mfma_f32_16x16x32_bf16 v[68:71], v[176:179], v[220:223], v[68:71]
    ds_read_b64_tr_b16 v[152:153], v24 offset:32
    v_mfma_f32_16x16x32_bf16 v[72:75], v[176:179], v[224:227], v[72:75]
    ds_read_b64_tr_b16 v[154:155], v24 offset:3616
    v_mfma_f32_16x16x32_bf16 v[76:79], v[180:183], v[216:219], v[76:79]
    ds_read_b64_tr_b16 v[156:157], v24 offset:64
    v_mfma_f32_16x16x32_bf16 v[80:83], v[180:183], v[220:223], v[80:83]
    ds_read_b64_tr_b16 v[158:159], v24 offset:3648
    v_mfma_f32_16x16x32_bf16 v[84:87], v[180:183], v[224:227], v[84:87]
    ds_read_b64_tr_b16 v[160:161], v24 offset:96
    v_mfma_f32_16x16x32_bf16 v[88:91], v[184:187], v[216:219], v[88:91]
    ds_read_b64_tr_b16 v[162:163], v24 offset:3680
    v_mfma_f32_16x16x32_bf16 v[92:95], v[184:187], v[220:223], v[92:95]
    ds_read_b64_tr_b16 v[164:165], v24 offset:128
    v_mfma_f32_16x16x32_bf16 v[96:99], v[184:187], v[224:227], v[96:99]
    ds_read_b64_tr_b16 v[166:167], v24 offset:3712
    v_mfma_f32_16x16x32_bf16 v[100:103], v[188:191], v[216:219], v[100:103]
    ds_read_b64_tr_b16 v[168:169], v24 offset:160
    v_mfma_f32_16x16x32_bf16 v[104:107], v[188:191], v[220:223], v[104:107]
    ds_read_b64_tr_b16 v[170:171], v24 offset:3744
    v_mfma_f32_16x16x32_bf16 v[108:111], v[188:191], v[224:227], v[108:111]
    ds_read_b64_tr_b16 v[172:173], v24 offset:192
    v_mfma_f32_16x16x32_bf16 v[112:115], v[192:195], v[216:219], v[112:115]
    ds_read_b64_tr_b16 v[174:175], v24 offset:3776
    v_mfma_f32_16x16x32_bf16 v[116:119], v[192:195], v[220:223], v[116:119]
    ds_read_b128 v[204:207], v30 offset:0
    v_mfma_f32_16x16x32_bf16 v[120:123], v[192:195], v[224:227], v[120:123]
    ds_read_b128 v[208:211], v30 offset:1024
    v_mfma_f32_16x16x32_bf16 v[124:127], v[196:199], v[216:219], v[124:127]
    ds_read_b128 v[212:215], v30 offset:2048
    v_mfma_f32_16x16x32_bf16 v[128:131], v[196:199], v[220:223], v[128:131]
    v_mfma_f32_16x16x32_bf16 v[132:135], v[196:199], v[224:227], v[132:135]
    v_mfma_f32_16x16x32_bf16 v[136:139], v[200:203], v[216:219], v[136:139]
    v_mfma_f32_16x16x32_bf16 v[140:143], v[200:203], v[220:223], v[140:143]
    v_mfma_f32_16x16x32_bf16 v[144:147], v[200:203], v[224:227], v[144:147]
    s_waitcnt vmcnt(0)
    s_add_u32 s58, s3, 7
    s_and_b32 s58, s58, 7
    s_mul_i32 s58, s58, 3072
    v_add_u32 v31, s58, v25
    s_waitcnt lgkmcnt(0)
    ds_read_b64_tr_b16 v[176:177], v24 offset:7168
    v_mfma_f32_16x16x32_bf16 v[64:67], v[148:151], v[204:207], v[64:67]
    ds_read_b64_tr_b16 v[178:179], v24 offset:10752
    v_mfma_f32_16x16x32_bf16 v[68:71], v[148:151], v[208:211], v[68:71]
    ds_read_b64_tr_b16 v[180:181], v24 offset:7200
    v_mfma_f32_16x16x32_bf16 v[72:75], v[148:151], v[212:215], v[72:75]
    ds_read_b64_tr_b16 v[182:183], v24 offset:10784
    v_mfma_f32_16x16x32_bf16 v[76:79], v[152:155], v[204:207], v[76:79]
    ds_read_b64_tr_b16 v[184:185], v24 offset:7232
    v_mfma_f32_16x16x32_bf16 v[80:83], v[152:155], v[208:211], v[80:83]
    ds_read_b64_tr_b16 v[186:187], v24 offset:10816
    v_mfma_f32_16x16x32_bf16 v[84:87], v[152:155], v[212:215], v[84:87]
    ds_read_b64_tr_b16 v[188:189], v24 offset:7264
    v_mfma_f32_16x16x32_bf16 v[88:91], v[156:159], v[204:207], v[88:91]
    ds_read_b64_tr_b16 v[190:191], v24 offset:10848
    v_mfma_f32_16x16x32_bf16 v[92:95], v[156:159], v[208:211], v[92:95]
    ds_read_b64_tr_b16 v[192:193], v24 offset:7296
    v_mfma_f32_16x16x32_bf16 v[96:99], v[156:159], v[212:215], v[96:99]
    ds_read_b64_tr_b16 v[194:195], v24 offset:10880
    v_mfma_f32_16x16x32_bf16 v[100:103], v[160:163], v[204:207], v[100:103]
    ds_read_b64_tr_b16 v[196:197], v24 offset:7328
    v_mfma_f32_16x16x32_bf16 v[104:107], v[160:163], v[208:211], v[104:107]
    ds_read_b64_tr_b16 v[198:199], v24 offset:10912
    v_mfma_f32_16x16x32_bf16 v[108:111], v[160:163], v[212:215], v[108:111]
    ds_read_b64_tr_b16 v[200:201], v24 offset:7360
    v_mfma_f32_16x16x32_bf16 v[112:115], v[164:167], v[204:207], v[112:115]
    ds_read_b64_tr_b16 v[202:203], v24 offset:10944
    v_mfma_f32_16x16x32_bf16 v[116:119], v[164:167], v[208:211], v[116:119]
    ds_read_b128 v[216:219], v31 offset:0
    v_mfma_f32_16x16x32_bf16 v[120:123], v[164:167], v[212:215], v[120:123]
    ds_read_b128 v[220:223], v31 offset:1024
    v_mfma_f32_16x16x32_bf16 v[124:127], v[168:171], v[204:207], v[124:127]
    ds_read_b128 v[224:227], v31 offset:2048
    v_mfma_f32_16x16x32_bf16 v[128:131], v[168:171], v[208:211], v[128:131]
    v_mfma_f32_16x16x32_bf16 v[132:135], v[168:171], v[212:215], v[132:135]
    v_mfma_f32_16x16x32_bf16 v[136:139], v[172:175], v[204:207], v[136:139]
    v_mfma_f32_16x16x32_bf16 v[140:143], v[172:175], v[208:211], v[140:143]
    v_mfma_f32_16x16x32_bf16 v[144:147], v[172:175], v[212:215], v[144:147]
    s_waitcnt lgkmcnt(0)
    v_mfma_f32_16x16x32_bf16 v[64:67], v[176:179], v[216:219], v[64:67]
    v_mfma_f32_16x16x32_bf16 v[68:71], v[176:179], v[220:223], v[68:71]
    v_mfma_f32_16x16x32_bf16 v[72:75], v[176:179], v[224:227], v[72:75]
    v_mfma_f32_16x16x32_bf16 v[76:79], v[180:183], v[216:219], v[76:79]
    v_mfma_f32_16x16x32_bf16 v[80:83], v[180:183], v[220:223], v[80:83]
    v_mfma_f32_16x16x32_bf16 v[84:87], v[180:183], v[224:227], v[84:87]
    v_mfma_f32_16x16x32_bf16 v[88:91], v[184:187], v[216:219], v[88:91]
    v_mfma_f32_16x16x32_bf16 v[92:95], v[184:187], v[220:223], v[92:95]
    v_mfma_f32_16x16x32_bf16 v[96:99], v[184:187], v[224:227], v[96:99]
    v_mfma_f32_16x16x32_bf16 v[100:103], v[188:191], v[216:219], v[100:103]
    v_mfma_f32_16x16x32_bf16 v[104:107], v[188:191], v[220:223], v[104:107]
    v_mfma_f32_16x16x32_bf16 v[108:111], v[188:191], v[224:227], v[108:111]
    v_mfma_f32_16x16x32_bf16 v[112:115], v[192:195], v[216:219], v[112:115]
    v_mfma_f32_16x16x32_bf16 v[116:119], v[192:195], v[220:223], v[116:119]
    v_mfma_f32_16x16x32_bf16 v[120:123], v[192:195], v[224:227], v[120:123]
    v_mfma_f32_16x16x32_bf16 v[124:127], v[196:199], v[216:219], v[124:127]
    v_mfma_f32_16x16x32_bf16 v[128:131], v[196:199], v[220:223], v[128:131]
    v_mfma_f32_16x16x32_bf16 v[132:135], v[196:199], v[224:227], v[132:135]
    v_mfma_f32_16x16x32_bf16 v[136:139], v[200:203], v[216:219], v[136:139]
    v_mfma_f32_16x16x32_bf16 v[140:143], v[200:203], v[220:223], v[140:143]
    v_mfma_f32_16x16x32_bf16 v[144:147], v[200:203], v[224:227], v[144:147]
    s_barrier
    v_mul_u32_u24 v28, 912, v2
    v_lshl_add_u32 v28, v3, 3, v28
    s_mul_i32 s58, s46, 224
    v_add_u32 v28, s58, v28
    v_cvt_pk_bf16_f32 v148, v64, v65
    v_cvt_pk_bf16_f32 v149, v66, v67
    ds_write_b64 v28, v[148:149] offset:0
    v_cvt_pk_bf16_f32 v150, v76, v77
    v_cvt_pk_bf16_f32 v151, v78, v79
    ds_write_b64 v28, v[150:151] offset:32
    v_cvt_pk_bf16_f32 v152, v88, v89
    v_cvt_pk_bf16_f32 v153, v90, v91
    ds_write_b64 v28, v[152:153] offset:64
    v_cvt_pk_bf16_f32 v154, v100, v101
    v_cvt_pk_bf16_f32 v155, v102, v103
    ds_write_b64 v28, v[154:155] offset:96
    v_cvt_pk_bf16_f32 v156, v112, v113
    v_cvt_pk_bf16_f32 v157, v114, v115
    ds_write_b64 v28, v[156:157] offset:128
    v_cvt_pk_bf16_f32 v158, v124, v125
    v_cvt_pk_bf16_f32 v159, v126, v127
    ds_write_b64 v28, v[158:159] offset:160
    v_cvt_pk_bf16_f32 v160, v136, v137
    v_cvt_pk_bf16_f32 v161, v138, v139
    ds_write_b64 v28, v[160:161] offset:192
    v_cvt_pk_bf16_f32 v162, v68, v69
    v_cvt_pk_bf16_f32 v163, v70, v71
    ds_write_b64 v28, v[162:163] offset:14592
    v_cvt_pk_bf16_f32 v164, v80, v81
    v_cvt_pk_bf16_f32 v165, v82, v83
    ds_write_b64 v28, v[164:165] offset:14624
    v_cvt_pk_bf16_f32 v166, v92, v93
    v_cvt_pk_bf16_f32 v167, v94, v95
    ds_write_b64 v28, v[166:167] offset:14656
    v_cvt_pk_bf16_f32 v168, v104, v105
    v_cvt_pk_bf16_f32 v169, v106, v107
    ds_write_b64 v28, v[168:169] offset:14688
    v_cvt_pk_bf16_f32 v170, v116, v117
    v_cvt_pk_bf16_f32 v171, v118, v119
    ds_write_b64 v28, v[170:171] offset:14720
    v_cvt_pk_bf16_f32 v172, v128, v129
    v_cvt_pk_bf16_f32 v173, v130, v131
    ds_write_b64 v28, v[172:173] offset:14752
    v_cvt_pk_bf16_f32 v174, v140, v141
    v_cvt_pk_bf16_f32 v175, v142, v143
    ds_write_b64 v28, v[174:175] offset:14784
    v_cvt_pk_bf16_f32 v176, v72, v73
    v_cvt_pk_bf16_f32 v177, v74, v75
    ds_write_b64 v28, v[176:177] offset:29184
    v_cvt_pk_bf16_f32 v178, v84, v85
    v_cvt_pk_bf16_f32 v179, v86, v87
    ds_write_b64 v28, v[178:179] offset:29216
    v_cvt_pk_bf16_f32 v180, v96, v97
    v_cvt_pk_bf16_f32 v181, v98, v99
    ds_write_b64 v28, v[180:181] offset:29248
    v_cvt_pk_bf16_f32 v182, v108, v109
    v_cvt_pk_bf16_f32 v183, v110, v111
    ds_write_b64 v28, v[182:183] offset:29280
    v_cvt_pk_bf16_f32 v184, v120, v121
    v_cvt_pk_bf16_f32 v185, v122, v123
    ds_write_b64 v28, v[184:185] offset:29312
    v_cvt_pk_bf16_f32 v186, v132, v133
    v_cvt_pk_bf16_f32 v187, v134, v135
    ds_write_b64 v28, v[186:187] offset:29344
    v_cvt_pk_bf16_f32 v188, v144, v145
    v_cvt_pk_bf16_f32 v189, v146, v147
    ds_write_b64 v28, v[188:189] offset:29376
    s_waitcnt lgkmcnt(0)
    s_barrier
    s_mov_b64 s[66:67], exec
    s_mov_b32 exec_lo, -1
    s_mov_b32 exec_hi, 0x00ffffff
    s_mul_i32 s58, s46, 10944
    v_add_u32 v28, s58, v25
    ds_read_b128 v[64:67], v28 offset:0
    ds_read_b128 v[68:71], v28 offset:912
    ds_read_b128 v[72:75], v28 offset:1824
    ds_read_b128 v[76:79], v28 offset:2736
    ds_read_b128 v[80:83], v28 offset:3648
    ds_read_b128 v[84:87], v28 offset:4560
    ds_read_b128 v[88:91], v28 offset:5472
    ds_read_b128 v[92:95], v28 offset:6384
    ds_read_b128 v[96:99], v28 offset:7296
    ds_read_b128 v[100:103], v28 offset:8208
    ds_read_b128 v[104:107], v28 offset:9120
    ds_read_b128 v[108:111], v28 offset:10032
    s_mul_i32 s58, s44, 688128
    s_mul_i32 s59, s46, 172032
    s_add_u32 s58, s58, s59
    s_mul_i32 s59, s45, 896
    s_add_u32 s58, s58, s59
    s_waitcnt lgkmcnt(11)
    buffer_store_dwordx4 v[64:67], v25, s[40:43], s58 offen
    s_add_u32 s58, s58, 14336
    s_waitcnt lgkmcnt(10)
    buffer_store_dwordx4 v[68:71], v25, s[40:43], s58 offen
    s_add_u32 s58, s58, 14336
    s_waitcnt lgkmcnt(9)
    buffer_store_dwordx4 v[72:75], v25, s[40:43], s58 offen
    s_add_u32 s58, s58, 14336
    s_waitcnt lgkmcnt(8)
    buffer_store_dwordx4 v[76:79], v25, s[40:43], s58 offen
    s_add_u32 s58, s58, 14336
    s_waitcnt lgkmcnt(7)
    buffer_store_dwordx4 v[80:83], v25, s[40:43], s58 offen
    s_add_u32 s58, s58, 14336
    s_waitcnt lgkmcnt(6)
    buffer_store_dwordx4 v[84:87], v25, s[40:43], s58 offen
    s_add_u32 s58, s58, 14336
    s_waitcnt lgkmcnt(5)
    buffer_store_dwordx4 v[88:91], v25, s[40:43], s58 offen
    s_add_u32 s58, s58, 14336
    s_waitcnt lgkmcnt(4)
    buffer_store_dwordx4 v[92:95], v25, s[40:43], s58 offen
    s_add_u32 s58, s58, 14336
    s_waitcnt lgkmcnt(3)
    buffer_store_dwordx4 v[96:99], v25, s[40:43], s58 offen
    s_add_u32 s58, s58, 14336
    s_waitcnt lgkmcnt(2)
    buffer_store_dwordx4 v[100:103], v25, s[40:43], s58 offen
    s_add_u32 s58, s58, 14336
    s_waitcnt lgkmcnt(1)
    buffer_store_dwordx4 v[104:107], v25, s[40:43], s58 offen
    s_add_u32 s58, s58, 14336
    s_waitcnt lgkmcnt(0)
    buffer_store_dwordx4 v[108:111], v25, s[40:43], s58 offen
    s_mov_b64 exec, s[66:67]
    s_branch K1_FIN
    s_waitcnt vmcnt(0)
    s_barrier
    s_cmp_lg_u32 s46, 0
    s_cbranch_scc1 K1_POLLED
    s_mov_b32 s68, s16
    s_mov_b32 s69, s17
    s_lshl_b32 s58, s44, 4
    s_add_u32 s68, s68, s58
    s_addc_u32 s69, s69, 0
    v_mov_b32 v28, s45
    v_mov_b32 v29, 1
    v_mov_b32 v31, 0
    s_mov_b64 exec, 1
    global_store_byte v28, v29, s[68:69] sc1
    s_mov_b32 s48, 0
    s_mov_b32 s3, 0x01010101
K1_POLL:
    global_load_dwordx4 v[232:235], v31, s[68:69] sc1
    s_waitcnt vmcnt(0)
    v_and_b32 v232, v232, v233
    v_and_b32 v234, v234, v235
    v_and_b32 v232, v232, v234
    s_nop 0
    v_readfirstlane_b32 s49, v232
    s_add_u32 s48, s48, 1
    s_cmp_eq_u32 s49, s3
    s_cbranch_scc1 K1_POLL_OK
    s_sleep 1
    s_cmp_lt_u32 s48, 0x400000
    s_cbranch_scc1 K1_POLL
K1_POLL_OK:
    s_mov_b64 exec, s[66:67]
K1_POLLED:
    s_barrier
    s_cmp_ge_u32 s46, 3
    s_cbranch_scc1 K1_RED_DONE
    s_mov_b32 exec_lo, -1
    s_mov_b32 exec_hi, 0x00ffffff
    s_mul_i32 s58, s44, 48
    s_mul_i32 s59, s45, 3
    s_add_u32 s58, s58, s59
    s_add_u32 s58, s58, s46
    s_mul_i32 s59, s58, 14336
    buffer_load_dwordx4 v[64:67], v25, s[40:43], s59 offen sc1
    s_add_u32 s59, s59, 896
    buffer_load_dwordx4 v[68:71], v25, s[40:43], s59 offen sc1
    s_add_u32 s59, s59, 896
    buffer_load_dwordx4 v[72:75], v25, s[40:43], s59 offen sc1
    s_add_u32 s59, s59, 896
    buffer_load_dwordx4 v[76:79], v25, s[40:43], s59 offen sc1
    s_add_u32 s59, s59, 896
    buffer_load_dwordx4 v[80:83], v25, s[40:43], s59 offen sc1
    s_add_u32 s59, s59, 896
    buffer_load_dwordx4 v[84:87], v25, s[40:43], s59 offen sc1
    s_add_u32 s59, s59, 896
    buffer_load_dwordx4 v[88:91], v25, s[40:43], s59 offen sc1
    s_add_u32 s59, s59, 896
    buffer_load_dwordx4 v[92:95], v25, s[40:43], s59 offen sc1
    s_add_u32 s59, s59, 896
    buffer_load_dwordx4 v[96:99], v25, s[40:43], s59 offen sc1
    s_add_u32 s59, s59, 896
    buffer_load_dwordx4 v[100:103], v25, s[40:43], s59 offen sc1
    s_add_u32 s59, s59, 896
    buffer_load_dwordx4 v[104:107], v25, s[40:43], s59 offen sc1
    s_add_u32 s59, s59, 896
    buffer_load_dwordx4 v[108:111], v25, s[40:43], s59 offen sc1
    s_add_u32 s59, s59, 896
    buffer_load_dwordx4 v[112:115], v25, s[40:43], s59 offen sc1
    s_add_u32 s59, s59, 896
    buffer_load_dwordx4 v[116:119], v25, s[40:43], s59 offen sc1
    s_add_u32 s59, s59, 896
    buffer_load_dwordx4 v[120:123], v25, s[40:43], s59 offen sc1
    s_add_u32 s59, s59, 896
    buffer_load_dwordx4 v[124:127], v25, s[40:43], s59 offen sc1
    s_mov_b32 s49, 0xffff0000
    s_waitcnt vmcnt(15)
    v_lshlrev_b32 v140, 16, v64
    v_and_b32 v141, s49, v64
    v_lshlrev_b32 v142, 16, v65
    v_and_b32 v143, s49, v65
    v_lshlrev_b32 v144, 16, v66
    v_and_b32 v145, s49, v66
    v_lshlrev_b32 v146, 16, v67
    v_and_b32 v147, s49, v67
    s_waitcnt vmcnt(14)
    v_lshlrev_b32 v150, 16, v68
    v_and_b32 v151, s49, v68
    v_lshlrev_b32 v152, 16, v69
    v_and_b32 v153, s49, v69
    v_lshlrev_b32 v154, 16, v70
    v_and_b32 v155, s49, v70
    v_lshlrev_b32 v156, 16, v71
    v_and_b32 v157, s49, v71
    v_pk_add_f32 v[140:141], v[140:141], v[150:151]
    v_pk_add_f32 v[142:143], v[142:143], v[152:153]
    v_pk_add_f32 v[144:145], v[144:145], v[154:155]
    v_pk_add_f32 v[146:147], v[146:147], v[156:157]
    s_waitcnt vmcnt(13)
    v_lshlrev_b32 v150, 16, v72
    v_and_b32 v151, s49, v72
    v_lshlrev_b32 v152, 16, v73
    v_and_b32 v153, s49, v73
    v_lshlrev_b32 v154, 16, v74
    v_and_b32 v155, s49, v74
    v_lshlrev_b32 v156, 16, v75
    v_and_b32 v157, s49, v75
    v_pk_add_f32 v[140:141], v[140:141], v[150:151]
    v_pk_add_f32 v[142:143], v[142:143], v[152:153]
    v_pk_add_f32 v[144:145], v[144:145], v[154:155]
    v_pk_add_f32 v[146:147], v[146:147], v[156:157]
    s_waitcnt vmcnt(12)
    v_lshlrev_b32 v150, 16, v76
    v_and_b32 v151, s49, v76
    v_lshlrev_b32 v152, 16, v77
    v_and_b32 v153, s49, v77
    v_lshlrev_b32 v154, 16, v78
    v_and_b32 v155, s49, v78
    v_lshlrev_b32 v156, 16, v79
    v_and_b32 v157, s49, v79
    v_pk_add_f32 v[140:141], v[140:141], v[150:151]
    v_pk_add_f32 v[142:143], v[142:143], v[152:153]
    v_pk_add_f32 v[144:145], v[144:145], v[154:155]
    v_pk_add_f32 v[146:147], v[146:147], v[156:157]
    s_waitcnt vmcnt(11)
    v_lshlrev_b32 v150, 16, v80
    v_and_b32 v151, s49, v80
    v_lshlrev_b32 v152, 16, v81
    v_and_b32 v153, s49, v81
    v_lshlrev_b32 v154, 16, v82
    v_and_b32 v155, s49, v82
    v_lshlrev_b32 v156, 16, v83
    v_and_b32 v157, s49, v83
    v_pk_add_f32 v[140:141], v[140:141], v[150:151]
    v_pk_add_f32 v[142:143], v[142:143], v[152:153]
    v_pk_add_f32 v[144:145], v[144:145], v[154:155]
    v_pk_add_f32 v[146:147], v[146:147], v[156:157]
    s_waitcnt vmcnt(10)
    v_lshlrev_b32 v150, 16, v84
    v_and_b32 v151, s49, v84
    v_lshlrev_b32 v152, 16, v85
    v_and_b32 v153, s49, v85
    v_lshlrev_b32 v154, 16, v86
    v_and_b32 v155, s49, v86
    v_lshlrev_b32 v156, 16, v87
    v_and_b32 v157, s49, v87
    v_pk_add_f32 v[140:141], v[140:141], v[150:151]
    v_pk_add_f32 v[142:143], v[142:143], v[152:153]
    v_pk_add_f32 v[144:145], v[144:145], v[154:155]
    v_pk_add_f32 v[146:147], v[146:147], v[156:157]
    s_waitcnt vmcnt(9)
    v_lshlrev_b32 v150, 16, v88
    v_and_b32 v151, s49, v88
    v_lshlrev_b32 v152, 16, v89
    v_and_b32 v153, s49, v89
    v_lshlrev_b32 v154, 16, v90
    v_and_b32 v155, s49, v90
    v_lshlrev_b32 v156, 16, v91
    v_and_b32 v157, s49, v91
    v_pk_add_f32 v[140:141], v[140:141], v[150:151]
    v_pk_add_f32 v[142:143], v[142:143], v[152:153]
    v_pk_add_f32 v[144:145], v[144:145], v[154:155]
    v_pk_add_f32 v[146:147], v[146:147], v[156:157]
    s_waitcnt vmcnt(8)
    v_lshlrev_b32 v150, 16, v92
    v_and_b32 v151, s49, v92
    v_lshlrev_b32 v152, 16, v93
    v_and_b32 v153, s49, v93
    v_lshlrev_b32 v154, 16, v94
    v_and_b32 v155, s49, v94
    v_lshlrev_b32 v156, 16, v95
    v_and_b32 v157, s49, v95
    v_pk_add_f32 v[140:141], v[140:141], v[150:151]
    v_pk_add_f32 v[142:143], v[142:143], v[152:153]
    v_pk_add_f32 v[144:145], v[144:145], v[154:155]
    v_pk_add_f32 v[146:147], v[146:147], v[156:157]
    s_waitcnt vmcnt(7)
    v_lshlrev_b32 v150, 16, v96
    v_and_b32 v151, s49, v96
    v_lshlrev_b32 v152, 16, v97
    v_and_b32 v153, s49, v97
    v_lshlrev_b32 v154, 16, v98
    v_and_b32 v155, s49, v98
    v_lshlrev_b32 v156, 16, v99
    v_and_b32 v157, s49, v99
    v_pk_add_f32 v[140:141], v[140:141], v[150:151]
    v_pk_add_f32 v[142:143], v[142:143], v[152:153]
    v_pk_add_f32 v[144:145], v[144:145], v[154:155]
    v_pk_add_f32 v[146:147], v[146:147], v[156:157]
    s_waitcnt vmcnt(6)
    v_lshlrev_b32 v150, 16, v100
    v_and_b32 v151, s49, v100
    v_lshlrev_b32 v152, 16, v101
    v_and_b32 v153, s49, v101
    v_lshlrev_b32 v154, 16, v102
    v_and_b32 v155, s49, v102
    v_lshlrev_b32 v156, 16, v103
    v_and_b32 v157, s49, v103
    v_pk_add_f32 v[140:141], v[140:141], v[150:151]
    v_pk_add_f32 v[142:143], v[142:143], v[152:153]
    v_pk_add_f32 v[144:145], v[144:145], v[154:155]
    v_pk_add_f32 v[146:147], v[146:147], v[156:157]
    s_waitcnt vmcnt(5)
    v_lshlrev_b32 v150, 16, v104
    v_and_b32 v151, s49, v104
    v_lshlrev_b32 v152, 16, v105
    v_and_b32 v153, s49, v105
    v_lshlrev_b32 v154, 16, v106
    v_and_b32 v155, s49, v106
    v_lshlrev_b32 v156, 16, v107
    v_and_b32 v157, s49, v107
    v_pk_add_f32 v[140:141], v[140:141], v[150:151]
    v_pk_add_f32 v[142:143], v[142:143], v[152:153]
    v_pk_add_f32 v[144:145], v[144:145], v[154:155]
    v_pk_add_f32 v[146:147], v[146:147], v[156:157]
    s_waitcnt vmcnt(4)
    v_lshlrev_b32 v150, 16, v108
    v_and_b32 v151, s49, v108
    v_lshlrev_b32 v152, 16, v109
    v_and_b32 v153, s49, v109
    v_lshlrev_b32 v154, 16, v110
    v_and_b32 v155, s49, v110
    v_lshlrev_b32 v156, 16, v111
    v_and_b32 v157, s49, v111
    v_pk_add_f32 v[140:141], v[140:141], v[150:151]
    v_pk_add_f32 v[142:143], v[142:143], v[152:153]
    v_pk_add_f32 v[144:145], v[144:145], v[154:155]
    v_pk_add_f32 v[146:147], v[146:147], v[156:157]
    s_waitcnt vmcnt(3)
    v_lshlrev_b32 v150, 16, v112
    v_and_b32 v151, s49, v112
    v_lshlrev_b32 v152, 16, v113
    v_and_b32 v153, s49, v113
    v_lshlrev_b32 v154, 16, v114
    v_and_b32 v155, s49, v114
    v_lshlrev_b32 v156, 16, v115
    v_and_b32 v157, s49, v115
    v_pk_add_f32 v[140:141], v[140:141], v[150:151]
    v_pk_add_f32 v[142:143], v[142:143], v[152:153]
    v_pk_add_f32 v[144:145], v[144:145], v[154:155]
    v_pk_add_f32 v[146:147], v[146:147], v[156:157]
    s_waitcnt vmcnt(2)
    v_lshlrev_b32 v150, 16, v116
    v_and_b32 v151, s49, v116
    v_lshlrev_b32 v152, 16, v117
    v_and_b32 v153, s49, v117
    v_lshlrev_b32 v154, 16, v118
    v_and_b32 v155, s49, v118
    v_lshlrev_b32 v156, 16, v119
    v_and_b32 v157, s49, v119
    v_pk_add_f32 v[140:141], v[140:141], v[150:151]
    v_pk_add_f32 v[142:143], v[142:143], v[152:153]
    v_pk_add_f32 v[144:145], v[144:145], v[154:155]
    v_pk_add_f32 v[146:147], v[146:147], v[156:157]
    s_waitcnt vmcnt(1)
    v_lshlrev_b32 v150, 16, v120
    v_and_b32 v151, s49, v120
    v_lshlrev_b32 v152, 16, v121
    v_and_b32 v153, s49, v121
    v_lshlrev_b32 v154, 16, v122
    v_and_b32 v155, s49, v122
    v_lshlrev_b32 v156, 16, v123
    v_and_b32 v157, s49, v123
    v_pk_add_f32 v[140:141], v[140:141], v[150:151]
    v_pk_add_f32 v[142:143], v[142:143], v[152:153]
    v_pk_add_f32 v[144:145], v[144:145], v[154:155]
    v_pk_add_f32 v[146:147], v[146:147], v[156:157]
    s_waitcnt vmcnt(0)
    v_lshlrev_b32 v150, 16, v124
    v_and_b32 v151, s49, v124
    v_lshlrev_b32 v152, 16, v125
    v_and_b32 v153, s49, v125
    v_lshlrev_b32 v154, 16, v126
    v_and_b32 v155, s49, v126
    v_lshlrev_b32 v156, 16, v127
    v_and_b32 v157, s49, v127
    v_pk_add_f32 v[140:141], v[140:141], v[150:151]
    v_pk_add_f32 v[142:143], v[142:143], v[152:153]
    v_pk_add_f32 v[144:145], v[144:145], v[154:155]
    v_pk_add_f32 v[146:147], v[146:147], v[156:157]
    v_cvt_pk_bf16_f32 v160, v140, v141
    v_cvt_pk_bf16_f32 v161, v142, v143
    v_cvt_pk_bf16_f32 v162, v144, v145
    v_cvt_pk_bf16_f32 v163, v146, v147
    s_mul_i32 s58, s58, 896
    buffer_store_dwordx4 v[160:163], v25, s[96:99], s58 offen
    s_mov_b64 exec, s[66:67]
K1_RED_DONE:
K1_FIN:
    s_waitcnt vmcnt(0)
K1_END:
    s_endpgm
.globl k2_kernel
.p2align 8
.type k2_kernel,@function
k2_kernel:
    s_cmp_ge_u32 s2, 168
    s_cbranch_scc1 K2_END
    s_load_dwordx2 s[4:5], s[0:1], 40
    s_load_dwordx2 s[6:7], s[0:1], 56
    s_lshl_b32 s3, s2, 8
    v_add_u32 v1, s3, v0
    s_mov_b32 s16, 74899
    v_lshrrev_b32 v4, 3, v1
    s_movk_i32 s16, 9363
    v_mul_u32_u24 v2, s16, v4
    v_lshrrev_b32 v2, 16, v2
    v_mul_u32_u24 v3, 56, v2
    v_sub_u32 v3, v1, v3
    v_mul_u32_u24 v5, 896, v2
    v_lshl_add_u32 v5, v3, 4, v5
    s_movk_i32 s16, 14336
    v_mul_u32_u24 v6, s16, v2
    v_lshl_add_u32 v6, v3, 4, v6
    s_waitcnt lgkmcnt(0)
    s_mov_b32 s8, s4
    s_mov_b32 s9, s5
    s_mov_b32 s10, 688128
    s_mov_b32 s11, 0x00020000
    s_mov_b32 s12, s6
    s_mov_b32 s13, s7
    s_mov_b32 s14, 11010048
    s_mov_b32 s15, 0x00020000
    s_movk_i32 s16, 0
    buffer_load_dwordx4 v[64:67], v6, s[12:15], s16 offen
    s_movk_i32 s16, 896
    buffer_load_dwordx4 v[68:71], v6, s[12:15], s16 offen
    s_movk_i32 s16, 1792
    buffer_load_dwordx4 v[72:75], v6, s[12:15], s16 offen
    s_movk_i32 s16, 2688
    buffer_load_dwordx4 v[76:79], v6, s[12:15], s16 offen
    s_movk_i32 s16, 3584
    buffer_load_dwordx4 v[80:83], v6, s[12:15], s16 offen
    s_movk_i32 s16, 4480
    buffer_load_dwordx4 v[84:87], v6, s[12:15], s16 offen
    s_movk_i32 s16, 5376
    buffer_load_dwordx4 v[88:91], v6, s[12:15], s16 offen
    s_movk_i32 s16, 6272
    buffer_load_dwordx4 v[92:95], v6, s[12:15], s16 offen
    s_movk_i32 s16, 7168
    buffer_load_dwordx4 v[96:99], v6, s[12:15], s16 offen
    s_movk_i32 s16, 8064
    buffer_load_dwordx4 v[100:103], v6, s[12:15], s16 offen
    s_movk_i32 s16, 8960
    buffer_load_dwordx4 v[104:107], v6, s[12:15], s16 offen
    s_movk_i32 s16, 9856
    buffer_load_dwordx4 v[108:111], v6, s[12:15], s16 offen
    s_movk_i32 s16, 10752
    buffer_load_dwordx4 v[112:115], v6, s[12:15], s16 offen
    s_movk_i32 s16, 11648
    buffer_load_dwordx4 v[116:119], v6, s[12:15], s16 offen
    s_movk_i32 s16, 12544
    buffer_load_dwordx4 v[120:123], v6, s[12:15], s16 offen
    s_movk_i32 s16, 13440
    buffer_load_dwordx4 v[124:127], v6, s[12:15], s16 offen
    s_mov_b32 s49, 0xffff0000
    s_waitcnt vmcnt(15)
    v_lshlrev_b32 v140, 16, v64
    v_and_b32 v141, s49, v64
    v_lshlrev_b32 v142, 16, v65
    v_and_b32 v143, s49, v65
    v_lshlrev_b32 v144, 16, v66
    v_and_b32 v145, s49, v66
    v_lshlrev_b32 v146, 16, v67
    v_and_b32 v147, s49, v67
    s_waitcnt vmcnt(14)
    v_lshlrev_b32 v150, 16, v68
    v_and_b32 v151, s49, v68
    v_lshlrev_b32 v152, 16, v69
    v_and_b32 v153, s49, v69
    v_lshlrev_b32 v154, 16, v70
    v_and_b32 v155, s49, v70
    v_lshlrev_b32 v156, 16, v71
    v_and_b32 v157, s49, v71
    v_pk_add_f32 v[140:141], v[140:141], v[150:151]
    v_pk_add_f32 v[142:143], v[142:143], v[152:153]
    v_pk_add_f32 v[144:145], v[144:145], v[154:155]
    v_pk_add_f32 v[146:147], v[146:147], v[156:157]
    s_waitcnt vmcnt(13)
    v_lshlrev_b32 v150, 16, v72
    v_and_b32 v151, s49, v72
    v_lshlrev_b32 v152, 16, v73
    v_and_b32 v153, s49, v73
    v_lshlrev_b32 v154, 16, v74
    v_and_b32 v155, s49, v74
    v_lshlrev_b32 v156, 16, v75
    v_and_b32 v157, s49, v75
    v_pk_add_f32 v[140:141], v[140:141], v[150:151]
    v_pk_add_f32 v[142:143], v[142:143], v[152:153]
    v_pk_add_f32 v[144:145], v[144:145], v[154:155]
    v_pk_add_f32 v[146:147], v[146:147], v[156:157]
    s_waitcnt vmcnt(12)
    v_lshlrev_b32 v150, 16, v76
    v_and_b32 v151, s49, v76
    v_lshlrev_b32 v152, 16, v77
    v_and_b32 v153, s49, v77
    v_lshlrev_b32 v154, 16, v78
    v_and_b32 v155, s49, v78
    v_lshlrev_b32 v156, 16, v79
    v_and_b32 v157, s49, v79
    v_pk_add_f32 v[140:141], v[140:141], v[150:151]
    v_pk_add_f32 v[142:143], v[142:143], v[152:153]
    v_pk_add_f32 v[144:145], v[144:145], v[154:155]
    v_pk_add_f32 v[146:147], v[146:147], v[156:157]
    s_waitcnt vmcnt(11)
    v_lshlrev_b32 v150, 16, v80
    v_and_b32 v151, s49, v80
    v_lshlrev_b32 v152, 16, v81
    v_and_b32 v153, s49, v81
    v_lshlrev_b32 v154, 16, v82
    v_and_b32 v155, s49, v82
    v_lshlrev_b32 v156, 16, v83
    v_and_b32 v157, s49, v83
    v_pk_add_f32 v[140:141], v[140:141], v[150:151]
    v_pk_add_f32 v[142:143], v[142:143], v[152:153]
    v_pk_add_f32 v[144:145], v[144:145], v[154:155]
    v_pk_add_f32 v[146:147], v[146:147], v[156:157]
    s_waitcnt vmcnt(10)
    v_lshlrev_b32 v150, 16, v84
    v_and_b32 v151, s49, v84
    v_lshlrev_b32 v152, 16, v85
    v_and_b32 v153, s49, v85
    v_lshlrev_b32 v154, 16, v86
    v_and_b32 v155, s49, v86
    v_lshlrev_b32 v156, 16, v87
    v_and_b32 v157, s49, v87
    v_pk_add_f32 v[140:141], v[140:141], v[150:151]
    v_pk_add_f32 v[142:143], v[142:143], v[152:153]
    v_pk_add_f32 v[144:145], v[144:145], v[154:155]
    v_pk_add_f32 v[146:147], v[146:147], v[156:157]
    s_waitcnt vmcnt(9)
    v_lshlrev_b32 v150, 16, v88
    v_and_b32 v151, s49, v88
    v_lshlrev_b32 v152, 16, v89
    v_and_b32 v153, s49, v89
    v_lshlrev_b32 v154, 16, v90
    v_and_b32 v155, s49, v90
    v_lshlrev_b32 v156, 16, v91
    v_and_b32 v157, s49, v91
    v_pk_add_f32 v[140:141], v[140:141], v[150:151]
    v_pk_add_f32 v[142:143], v[142:143], v[152:153]
    v_pk_add_f32 v[144:145], v[144:145], v[154:155]
    v_pk_add_f32 v[146:147], v[146:147], v[156:157]
    s_waitcnt vmcnt(8)
    v_lshlrev_b32 v150, 16, v92
    v_and_b32 v151, s49, v92
    v_lshlrev_b32 v152, 16, v93
    v_and_b32 v153, s49, v93
    v_lshlrev_b32 v154, 16, v94
    v_and_b32 v155, s49, v94
    v_lshlrev_b32 v156, 16, v95
    v_and_b32 v157, s49, v95
    v_pk_add_f32 v[140:141], v[140:141], v[150:151]
    v_pk_add_f32 v[142:143], v[142:143], v[152:153]
    v_pk_add_f32 v[144:145], v[144:145], v[154:155]
    v_pk_add_f32 v[146:147], v[146:147], v[156:157]
    s_waitcnt vmcnt(7)
    v_lshlrev_b32 v150, 16, v96
    v_and_b32 v151, s49, v96
    v_lshlrev_b32 v152, 16, v97
    v_and_b32 v153, s49, v97
    v_lshlrev_b32 v154, 16, v98
    v_and_b32 v155, s49, v98
    v_lshlrev_b32 v156, 16, v99
    v_and_b32 v157, s49, v99
    v_pk_add_f32 v[140:141], v[140:141], v[150:151]
    v_pk_add_f32 v[142:143], v[142:143], v[152:153]
    v_pk_add_f32 v[144:145], v[144:145], v[154:155]
    v_pk_add_f32 v[146:147], v[146:147], v[156:157]
    s_waitcnt vmcnt(6)
    v_lshlrev_b32 v150, 16, v100
    v_and_b32 v151, s49, v100
    v_lshlrev_b32 v152, 16, v101
    v_and_b32 v153, s49, v101
    v_lshlrev_b32 v154, 16, v102
    v_and_b32 v155, s49, v102
    v_lshlrev_b32 v156, 16, v103
    v_and_b32 v157, s49, v103
    v_pk_add_f32 v[140:141], v[140:141], v[150:151]
    v_pk_add_f32 v[142:143], v[142:143], v[152:153]
    v_pk_add_f32 v[144:145], v[144:145], v[154:155]
    v_pk_add_f32 v[146:147], v[146:147], v[156:157]
    s_waitcnt vmcnt(5)
    v_lshlrev_b32 v150, 16, v104
    v_and_b32 v151, s49, v104
    v_lshlrev_b32 v152, 16, v105
    v_and_b32 v153, s49, v105
    v_lshlrev_b32 v154, 16, v106
    v_and_b32 v155, s49, v106
    v_lshlrev_b32 v156, 16, v107
    v_and_b32 v157, s49, v107
    v_pk_add_f32 v[140:141], v[140:141], v[150:151]
    v_pk_add_f32 v[142:143], v[142:143], v[152:153]
    v_pk_add_f32 v[144:145], v[144:145], v[154:155]
    v_pk_add_f32 v[146:147], v[146:147], v[156:157]
    s_waitcnt vmcnt(4)
    v_lshlrev_b32 v150, 16, v108
    v_and_b32 v151, s49, v108
    v_lshlrev_b32 v152, 16, v109
    v_and_b32 v153, s49, v109
    v_lshlrev_b32 v154, 16, v110
    v_and_b32 v155, s49, v110
    v_lshlrev_b32 v156, 16, v111
    v_and_b32 v157, s49, v111
    v_pk_add_f32 v[140:141], v[140:141], v[150:151]
    v_pk_add_f32 v[142:143], v[142:143], v[152:153]
    v_pk_add_f32 v[144:145], v[144:145], v[154:155]
    v_pk_add_f32 v[146:147], v[146:147], v[156:157]
    s_waitcnt vmcnt(3)
    v_lshlrev_b32 v150, 16, v112
    v_and_b32 v151, s49, v112
    v_lshlrev_b32 v152, 16, v113
    v_and_b32 v153, s49, v113
    v_lshlrev_b32 v154, 16, v114
    v_and_b32 v155, s49, v114
    v_lshlrev_b32 v156, 16, v115
    v_and_b32 v157, s49, v115
    v_pk_add_f32 v[140:141], v[140:141], v[150:151]
    v_pk_add_f32 v[142:143], v[142:143], v[152:153]
    v_pk_add_f32 v[144:145], v[144:145], v[154:155]
    v_pk_add_f32 v[146:147], v[146:147], v[156:157]
    s_waitcnt vmcnt(2)
    v_lshlrev_b32 v150, 16, v116
    v_and_b32 v151, s49, v116
    v_lshlrev_b32 v152, 16, v117
    v_and_b32 v153, s49, v117
    v_lshlrev_b32 v154, 16, v118
    v_and_b32 v155, s49, v118
    v_lshlrev_b32 v156, 16, v119
    v_and_b32 v157, s49, v119
    v_pk_add_f32 v[140:141], v[140:141], v[150:151]
    v_pk_add_f32 v[142:143], v[142:143], v[152:153]
    v_pk_add_f32 v[144:145], v[144:145], v[154:155]
    v_pk_add_f32 v[146:147], v[146:147], v[156:157]
    s_waitcnt vmcnt(1)
    v_lshlrev_b32 v150, 16, v120
    v_and_b32 v151, s49, v120
    v_lshlrev_b32 v152, 16, v121
    v_and_b32 v153, s49, v121
    v_lshlrev_b32 v154, 16, v122
    v_and_b32 v155, s49, v122
    v_lshlrev_b32 v156, 16, v123
    v_and_b32 v157, s49, v123
    v_pk_add_f32 v[140:141], v[140:141], v[150:151]
    v_pk_add_f32 v[142:143], v[142:143], v[152:153]
    v_pk_add_f32 v[144:145], v[144:145], v[154:155]
    v_pk_add_f32 v[146:147], v[146:147], v[156:157]
    s_waitcnt vmcnt(0)
    v_lshlrev_b32 v150, 16, v124
    v_and_b32 v151, s49, v124
    v_lshlrev_b32 v152, 16, v125
    v_and_b32 v153, s49, v125
    v_lshlrev_b32 v154, 16, v126
    v_and_b32 v155, s49, v126
    v_lshlrev_b32 v156, 16, v127
    v_and_b32 v157, s49, v127
    v_pk_add_f32 v[140:141], v[140:141], v[150:151]
    v_pk_add_f32 v[142:143], v[142:143], v[152:153]
    v_pk_add_f32 v[144:145], v[144:145], v[154:155]
    v_pk_add_f32 v[146:147], v[146:147], v[156:157]
    v_cvt_pk_bf16_f32 v160, v140, v141
    v_cvt_pk_bf16_f32 v161, v142, v143
    v_cvt_pk_bf16_f32 v162, v144, v145
    v_cvt_pk_bf16_f32 v163, v146, v147
    buffer_store_dwordx4 v[160:163], v5, s[8:11], 0 offen
    s_waitcnt vmcnt(0)
K2_END:
    s_endpgm
.section .rodata,"a"
.p2align 6
.amdhsa_kernel k1_kernel
  .amdhsa_next_free_vgpr 256
  .amdhsa_next_free_sgpr 100
  .amdhsa_accum_offset 256
  .amdhsa_group_segment_fixed_size 0
  .amdhsa_kernarg_size 64
  .amdhsa_user_sgpr_count 2
  .amdhsa_user_sgpr_kernarg_segment_ptr 1
  .amdhsa_system_sgpr_workgroup_id_x 1
.end_amdhsa_kernel
.p2align 6
.amdhsa_kernel k2_kernel
  .amdhsa_next_free_vgpr 168
  .amdhsa_next_free_sgpr 64
  .amdhsa_accum_offset 168
  .amdhsa_group_segment_fixed_size 0
  .amdhsa_kernarg_size 64
  .amdhsa_user_sgpr_count 2
  .amdhsa_user_sgpr_kernarg_segment_ptr 1
  .amdhsa_system_sgpr_workgroup_id_x 1
.end_amdhsa_kernel
```
